```python
import torch

def _softmax(x, axis=-1):
    return torch.softmax(x, dim=axis)
def _gelu(x):
    return torch.nn.functional.gelu(x, approximate="tanh")
def _silu(x):
    return torch.nn.functional.silu(x)
def _sigmoid(x):
    return torch.sigmoid(x)
def _layernorm(x, axis=-1, eps=1e-5):
    m = x.mean(dim=axis, keepdim=True)
    v = x.var(dim=axis, keepdim=True, unbiased=False)
    return (x - m) / torch.sqrt(v + eps)
def _scatter_add(tgt, idx, src, axis=0):
    return tgt.clone().index_add_(axis, idx, src)
def _segment_sum(src, seg, n):
    out = torch.zeros((n,) + src.shape[1:], dtype=src.dtype)
    return out.index_add_(0, seg, src)
def _pad(x, pw):
    flat = tuple(v for pair in reversed(pw) for v in pair)
    return torch.nn.functional.pad(x, flat)

kernel_name = 'standalone__gqa_block_cached__sampling'

def setup_inputs():

    _w = (lambda a: (lambda t: t.to(torch.bfloat16) if t.is_floating_point() else t)(torch.as_tensor(a)))
    B, Sq, D = 8, 4, 448
    Hq, Hkv, Sk, Dh = 16, 8, 8192, 256
    assert Hq % Hkv == 0, (Hq, Hkv)
    return {
        "x": _w((lambda *s: torch.randn(*s, dtype=torch.bfloat16) * 0.8)(B, Sq, D)),
        "k_cache": _w((lambda *s: torch.randn(*s, dtype=torch.bfloat16) * 0.8)(B, Hkv, Sk, Dh)),
        "v_cache": _w((lambda *s: torch.randn(*s, dtype=torch.bfloat16) * 0.05)(B, Hkv, Sk, Dh)),
        "wq": _w((lambda *s: torch.randn(*s, dtype=torch.bfloat16) * 0.8)(D, Hq * Dh) * (D ** -0.5)),
        "wo": _w((lambda *s: torch.randn(*s, dtype=torch.bfloat16) * 0.05)(Hq * Dh, D) * ((Hq * Dh) ** -0.5)),
    }

def reference(x, k_cache, v_cache, wq, wo):
    B, Sq, D = x.shape
    Hq, Dh = 16, 256
    Hkv = k_cache.shape[1]
    rep = Hq // Hkv
    q = (lambda x, *d: x.permute(*d))((x @ wq).reshape(B, Sq, Hq, Dh), 0, 2, 1, 3)
    k = (lambda x, n, axis: torch.repeat_interleave(x, n, dim=axis))(k_cache, rep, axis=1)
    v = (lambda x, n, axis: torch.repeat_interleave(x, n, dim=axis))(v_cache, rep, axis=1)
    scores = torch.einsum("bhqd,bhkd->bhqk", q, k) * (Dh ** -0.5)
    p = _softmax(scores, axis=-1)
    o = torch.einsum("bhqk,bhkd->bhqd", p, v)
    return (lambda x, *d: x.permute(*d))(o, 0, 2, 1, 3).reshape(B, Sq, Hq * Dh) @ wo
```

```asm
; @launch grid=(256,1,1) block=(512,1,1) lds=163840
.amdgcn_target "amdgcn-amd-amdhsa--gfx950"
.text
.globl standalone__gqa_block_cached__sampling_kernel
.p2align 8
.type standalone__gqa_block_cached__sampling_kernel,@function
standalone__gqa_block_cached__sampling_kernel:
  s_cmp_ge_u32 s2, 256
  s_cbranch_scc1 L_end
  s_load_dwordx16 s[32:47], s[0:1], 0
  v_lshrrev_b32 v67, 6, v0
  v_and_b32 v64, 63, v0
  s_and_b32 s72, s2, 7
  s_lshr_b32 s73, s2, 3
  v_readfirstlane_b32 s3, v67
  s_and_b32 s74, s72, 1
  s_mul_i32 s74, s74, 5
  s_xor_b32 s74, s74, s72
  s_and_b32 s4, s74, 6
  s_and_b32 s74, s73, 1
  s_add_u32 s4, s4, s74
  s_and_b32 s5, s72, 1
  s_and_b32 s74, s73, 2
  s_add_u32 s5, s5, s74
  s_lshr_b32 s6, s73, 2
  s_lshl_b32 s80, s6, 2
  s_add_u32 s80, s80, s5
  s_lshl_b32 s83, s80, 3
  s_add_u32 s83, s83, s4
  s_lshl_b32 s68, s6, 3
  s_add_u32 s68, s68, s4
  v_and_b32 v65, 15, v64
  v_lshrrev_b32 v66, 4, v64
  s_and_b32 s7, s3, 3
  s_lshl_b32 s69, s4, 2
  s_add_u32 s69, s69, s5
  s_cmp_ge_u32 s3, 4
  s_cbranch_scc1 L_helper
  v_lshrrev_b32 v94, 5, v64
  v_and_b32 v95, 31, v64
  v_lshlrev_b32 v96, 9, v94
  v_lshlrev_b32 v97, 1, v94
  v_xor_b32 v98, 0, v97
  v_xor_b32 v98, v98, v95
  v_lshl_add_u32 v68, v98, 4, v96
  v_xor_b32 v98, 4, v97
  v_xor_b32 v98, v98, v95
  v_lshl_add_u32 v69, v98, 4, v96
  v_xor_b32 v98, 8, v97
  v_xor_b32 v98, v98, v95
  v_lshl_add_u32 v70, v98, 4, v96
  v_add_u32 v70, 0x1800, v70
  v_xor_b32 v98, 12, v97
  v_xor_b32 v98, v98, v95
  v_lshl_add_u32 v71, v98, 4, v96
  v_add_u32 v71, 0x1800, v71
  s_lshl_b32 s60, s68, 22
  s_lshr_b32 s72, s5, 1
  s_lshl_b32 s72, s72, 21
  s_add_u32 s60, s60, s72
  s_and_b32 s73, s5, 1
  s_mul_i32 s72, s73, 2064384
  s_add_u32 s60, s60, s72
  s_mul_i32 s73, s73, -65536
  s_add_u32 s57, s73, 32768
  s_mov_b32 s56, 100000
  s_and_b32 s73, s3, 1
  s_lshl_b32 s73, s73, 11
  s_lshr_b32 s72, s3, 1
  s_and_b32 s72, s72, 1
  s_lshl_b32 s72, s72, 12
  s_or_b32 s72, s72, s73
  s_add_u32 s60, s60, s72
  s_lshl_b32 s62, s3, 15
  s_waitcnt lgkmcnt(0)
  s_mov_b32 s8, s34
  s_and_b32 s9, s35, 0xffff
  s_mov_b32 s10, 0x10000000
  s_mov_b32 s11, 0x20000
  s_mov_b32 s12, s36
  s_and_b32 s13, s37, 0xffff
  s_mov_b32 s14, 0x10000000
  s_mov_b32 s15, 0x20000
  s_add_u32 s77, s60, 0
  s_add_u32 m0, s62, 0
  s_nop 0
  buffer_load_dwordx4 v68, s[8:11], s77 offen nt lds
  buffer_load_dwordx4 v69, s[8:11], s77 offen offset:1024 nt lds
  buffer_load_dwordx4 v70, s[8:11], s77 offen offset:2048 nt lds
  buffer_load_dwordx4 v71, s[8:11], s77 offen offset:3072 nt lds
  s_add_u32 s77, s60, 16384
  s_add_u32 m0, s62, 4096
  s_nop 0
  buffer_load_dwordx4 v68, s[8:11], s77 offen nt lds
  buffer_load_dwordx4 v69, s[8:11], s77 offen offset:1024 nt lds
  buffer_load_dwordx4 v70, s[8:11], s77 offen offset:2048 nt lds
  buffer_load_dwordx4 v71, s[8:11], s77 offen offset:3072 nt lds
  s_barrier
  s_add_u32 s77, s60, 0
  s_add_u32 m0, s62, 16384
  s_nop 0
  buffer_load_dwordx4 v68, s[12:15], s77 offen nt lds
  buffer_load_dwordx4 v69, s[12:15], s77 offen offset:1024 nt lds
  buffer_load_dwordx4 v70, s[12:15], s77 offen offset:2048 nt lds
  buffer_load_dwordx4 v71, s[12:15], s77 offen offset:3072 nt lds
  s_add_u32 s77, s60, 16384
  s_add_u32 m0, s62, 20480
  s_nop 0
  buffer_load_dwordx4 v68, s[12:15], s77 offen nt lds
  buffer_load_dwordx4 v69, s[12:15], s77 offen offset:1024 nt lds
  buffer_load_dwordx4 v70, s[12:15], s77 offen offset:2048 nt lds
  buffer_load_dwordx4 v71, s[12:15], s77 offen offset:3072 nt lds
  s_mov_b32 s28, s46
  s_and_b32 s29, s47, 0xffff
  s_mov_b32 s30, 0x1000000
  s_mov_b32 s31, 0x20000
  v_and_b32 v94, 7, v65
  v_lshlrev_b32 v94, 1, v94
  v_lshlrev_b32 v95, 9, v65
  v_add_u32 v95, s62, v95
  v_add_u32 v96, 0, v66
  v_xor_b32 v96, v96, v94
  v_lshl_add_u32 v72, v96, 4, v95
  v_add_u32 v96, 4, v66
  v_xor_b32 v96, v96, v94
  v_lshl_add_u32 v73, v96, 4, v95
  v_add_u32 v96, 8, v66
  v_xor_b32 v96, v96, v94
  v_lshl_add_u32 v74, v96, 4, v95
  v_add_u32 v96, 12, v66
  v_xor_b32 v96, v96, v94
  v_lshl_add_u32 v75, v96, 4, v95
  v_lshrrev_b32 v94, 2, v65
  v_lshl_add_u32 v94, v66, 2, v94
  v_and_b32 v95, 7, v94
  v_lshlrev_b32 v96, 9, v94
  v_and_b32 v97, 3, v65
  v_lshl_add_u32 v96, v97, 3, v96
  s_add_u32 s72, s62, 16384
  v_add_u32 v96, s72, v96
  v_xor_b32 v97, 0, v95
  v_lshl_add_u32 v76, v97, 5, v96
  v_xor_b32 v97, 1, v95
  v_lshl_add_u32 v77, v97, 5, v96
  v_xor_b32 v97, 2, v95
  v_lshl_add_u32 v78, v97, 5, v96
  v_xor_b32 v97, 3, v95
  v_lshl_add_u32 v79, v97, 5, v96
  v_xor_b32 v97, 4, v95
  v_lshl_add_u32 v80, v97, 5, v96
  v_xor_b32 v97, 5, v95
  v_lshl_add_u32 v81, v97, 5, v96
  v_xor_b32 v97, 6, v95
  v_lshl_add_u32 v82, v97, 5, v96
  v_xor_b32 v97, 7, v95
  v_lshl_add_u32 v83, v97, 5, v96
  v_mov_b32 v0, 0
  v_mov_b32 v1, 0
  v_mov_b32 v2, 0
  v_mov_b32 v3, 0
  v_mov_b32 v4, 0
  v_mov_b32 v5, 0
  v_mov_b32 v6, 0
  v_mov_b32 v7, 0
  v_mov_b32 v8, 0
  v_mov_b32 v9, 0
  v_mov_b32 v10, 0
  v_mov_b32 v11, 0
  v_mov_b32 v12, 0
  v_mov_b32 v13, 0
  v_mov_b32 v14, 0
  v_mov_b32 v15, 0
  v_mov_b32 v16, 0
  v_mov_b32 v17, 0
  v_mov_b32 v18, 0
  v_mov_b32 v19, 0
  v_mov_b32 v20, 0
  v_mov_b32 v21, 0
  v_mov_b32 v22, 0
  v_mov_b32 v23, 0
  v_mov_b32 v24, 0
  v_mov_b32 v25, 0
  v_mov_b32 v26, 0
  v_mov_b32 v27, 0
  v_mov_b32 v28, 0
  v_mov_b32 v29, 0
  v_mov_b32 v30, 0
  v_mov_b32 v31, 0
  v_mov_b32 v32, 0
  v_mov_b32 v33, 0
  v_mov_b32 v34, 0
  v_mov_b32 v35, 0
  v_mov_b32 v36, 0
  v_mov_b32 v37, 0
  v_mov_b32 v38, 0
  v_mov_b32 v39, 0
  v_mov_b32 v40, 0
  v_mov_b32 v41, 0
  v_mov_b32 v42, 0
  v_mov_b32 v43, 0
  v_mov_b32 v44, 0
  v_mov_b32 v45, 0
  v_mov_b32 v46, 0
  v_mov_b32 v47, 0
  v_mov_b32 v48, 0
  v_mov_b32 v49, 0
  v_mov_b32 v50, 0
  v_mov_b32 v51, 0
  v_mov_b32 v52, 0
  v_mov_b32 v53, 0
  v_mov_b32 v54, 0
  v_mov_b32 v55, 0
  v_mov_b32 v56, 0
  v_mov_b32 v57, 0
  v_mov_b32 v58, 0
  v_mov_b32 v59, 0
  v_mov_b32 v60, 0
  v_mov_b32 v61, 0
  v_mov_b32 v62, 0
  v_mov_b32 v63, 0
  v_mov_b32 v90, 0xff7fffff
  v_mov_b32 v91, 0
  s_mov_b32 s66, 0x3db8aa3b
  s_mov_b32 s67, 0xbdb8aa3b
  v_lshlrev_b32 v104, 4, v64
  s_lshl_b32 s72, s68, 2
  s_add_u32 s72, s72, s3
  s_lshl_b32 s72, s72, 2
  s_add_u32 s72, s72, s5
  s_mul_i32 s70, s72, 2176
  s_lshl_b32 s58, s68, 22
  s_lshr_b32 s72, s5, 1
  s_lshl_b32 s72, s72, 21
  s_add_u32 s58, s58, s72
  s_and_b32 s59, s5, 1
  s_mul_i32 s59, s59, 255
  v_mov_b32 v109, 1
  v_mov_b32 v110, 136648
  s_and_b32 s55, s5, 1
  s_mul_i32 s55, s55, -20
  s_add_u32 s55, s55, 116
  s_movk_i32 s73, 528
  v_and_b32 v99, 7, v65
  v_mul_lo_u32 v99, v99, s73
  v_lshl_add_u32 v99, v66, 4, v99
  v_add_u32 v99, 131072, v99
  s_waitcnt vmcnt(12)
  s_add_u32 s77, s60, 0
  s_add_u32 s77, s77, s57
  s_add_u32 m0, s62, 8192
  s_nop 0
  buffer_load_dwordx4 v68, s[8:11], s77 offen nt lds
  buffer_load_dwordx4 v69, s[8:11], s77 offen offset:1024 nt lds
  buffer_load_dwordx4 v70, s[8:11], s77 offen offset:2048 nt lds
  buffer_load_dwordx4 v71, s[8:11], s77 offen offset:3072 nt lds
  s_waitcnt vmcnt(12)
  s_add_u32 s77, s60, 16384
  s_add_u32 s77, s77, s57
  s_add_u32 m0, s62, 12288
  s_nop 0
  buffer_load_dwordx4 v68, s[8:11], s77 offen nt lds
  buffer_load_dwordx4 v69, s[8:11], s77 offen offset:1024 nt lds
  buffer_load_dwordx4 v70, s[8:11], s77 offen offset:2048 nt lds
  buffer_load_dwordx4 v71, s[8:11], s77 offen offset:3072 nt lds
  s_waitcnt vmcnt(12)
  s_add_u32 s77, s60, 0
  s_add_u32 s77, s77, s57
  s_add_u32 m0, s62, 24576
  s_nop 0
  buffer_load_dwordx4 v68, s[12:15], s77 offen nt lds
  buffer_load_dwordx4 v69, s[12:15], s77 offen offset:1024 nt lds
  buffer_load_dwordx4 v70, s[12:15], s77 offen offset:2048 nt lds
  buffer_load_dwordx4 v71, s[12:15], s77 offen offset:3072 nt lds
  s_waitcnt vmcnt(12)
  s_add_u32 s77, s60, 16384
  s_add_u32 s77, s77, s57
  s_add_u32 m0, s62, 28672
  s_nop 0
  buffer_load_dwordx4 v68, s[12:15], s77 offen nt lds
  buffer_load_dwordx4 v69, s[12:15], s77 offen offset:1024 nt lds
  buffer_load_dwordx4 v70, s[12:15], s77 offen offset:2048 nt lds
  buffer_load_dwordx4 v71, s[12:15], s77 offen offset:3072 nt lds
  s_waitcnt vmcnt(24)
  ds_read_b128 a[32:35], v72
  ds_read_b128 a[36:39], v73
  ds_read_b128 a[40:43], v74
  ds_read_b128 a[44:47], v75
  ds_read_b128 a[48:51], v72 offset:256
  ds_read_b128 a[52:55], v73 offset:256
  ds_read_b128 a[56:59], v74 offset:256
  ds_read_b128 a[60:63], v75 offset:256
  s_add_u32 s60, s60, s57
  s_add_u32 s60, s60, s57
  s_mov_b32 s61, s60
  s_mov_b32 s63, s62
  s_add_u32 s64, s62, 16384
  s_add_u32 s76, s60, 16384
  s_waitcnt vmcnt(12) lgkmcnt(0)
  s_mov_b32 m0, s63
  s_nop 0
  buffer_load_dwordx4 v68, s[8:11], s60 offen nt lds
  buffer_load_dwordx4 v69, s[8:11], s60 offen offset:1024 nt lds
  buffer_load_dwordx4 v70, s[8:11], s60 offen offset:2048 nt lds
  buffer_load_dwordx4 v71, s[8:11], s60 offen offset:3072 nt lds
  s_waitcnt vmcnt(12)
  s_add_u32 m0, s63, 4096
  s_nop 0
  buffer_load_dwordx4 v68, s[8:11], s76 offen nt lds
  buffer_load_dwordx4 v69, s[8:11], s76 offen offset:1024 nt lds
  buffer_load_dwordx4 v70, s[8:11], s76 offen offset:2048 nt lds
  buffer_load_dwordx4 v71, s[8:11], s76 offen offset:3072 nt lds
  s_add_u32 s60, s60, s57
  s_xor_b32 s63, s63, 8192
  v_xor_b32 v72, 8192, v72
  v_xor_b32 v73, 8192, v73
  v_xor_b32 v74, 8192, v74
  v_xor_b32 v75, 8192, v75
  s_waitcnt vmcnt(24)
  ds_read_b64_tr_b16 a[64:65], v76
  ds_read_b64_tr_b16 a[66:67], v77
  ds_read_b64_tr_b16 a[68:69], v78
  ds_read_b64_tr_b16 a[70:71], v79
  ds_read_b64_tr_b16 a[72:73], v80
  ds_read_b64_tr_b16 a[74:75], v81
  ds_read_b64_tr_b16 a[76:77], v82
  ds_read_b64_tr_b16 a[78:79], v83
  ds_read_b64_tr_b16 a[80:81], v76 offset:256
  ds_read_b64_tr_b16 a[82:83], v77 offset:256
  ds_read_b64_tr_b16 a[84:85], v78 offset:256
  ds_read_b64_tr_b16 a[86:87], v79 offset:256
  ds_read_b64_tr_b16 a[88:89], v80 offset:256
  ds_read_b64_tr_b16 a[90:91], v81 offset:256
  ds_read_b64_tr_b16 a[92:93], v82 offset:256
  ds_read_b64_tr_b16 a[94:95], v83 offset:256
  s_add_u32 s76, s61, 16384
  s_waitcnt vmcnt(12) lgkmcnt(0)
  s_mov_b32 m0, s64
  s_nop 0
  buffer_load_dwordx4 v68, s[12:15], s61 offen nt lds
  buffer_load_dwordx4 v69, s[12:15], s61 offen offset:1024 nt lds
  buffer_load_dwordx4 v70, s[12:15], s61 offen offset:2048 nt lds
  buffer_load_dwordx4 v71, s[12:15], s61 offen offset:3072 nt lds
  s_waitcnt vmcnt(12)
  s_add_u32 m0, s64, 4096
  s_nop 0
  buffer_load_dwordx4 v68, s[12:15], s76 offen nt lds
  buffer_load_dwordx4 v69, s[12:15], s76 offen offset:1024 nt lds
  buffer_load_dwordx4 v70, s[12:15], s76 offen offset:2048 nt lds
  buffer_load_dwordx4 v71, s[12:15], s76 offen offset:3072 nt lds
  s_add_u32 s61, s61, s57
  s_xor_b32 s64, s64, 8192
  v_xor_b32 v76, 8192, v76
  v_xor_b32 v77, 8192, v77
  v_xor_b32 v78, 8192, v78
  v_xor_b32 v79, 8192, v79
  v_xor_b32 v80, 8192, v80
  v_xor_b32 v81, 8192, v81
  v_xor_b32 v82, 8192, v82
  v_xor_b32 v83, 8192, v83
  s_barrier
  ds_read_b128 a[0:3], v99
  ds_read_b128 a[4:7], v99 offset:64
  ds_read_b128 a[8:11], v99 offset:128
  ds_read_b128 a[12:15], v99 offset:192
  ds_read_b128 a[16:19], v99 offset:256
  ds_read_b128 a[20:23], v99 offset:320
  ds_read_b128 a[24:27], v99 offset:384
  ds_read_b128 a[28:31], v99 offset:448
  s_mov_b32 s65, 0
  s_waitcnt lgkmcnt(0)
L_loop:
  s_sub_u32 s73, s56, 3
  s_cmp_ge_u32 s65, s73
  s_cbranch_scc1 L_nograb
  s_mov_b64 exec, 1
  ds_add_rtn_u32 v108, v110, v109
  s_mov_b64 exec, -1
L_nograb:
  v_mfma_f32_16x16x32_bf16 v[84:87], a[32:35], a[0:3], 0
  v_mfma_f32_16x16x32_bf16 v[84:87], a[36:39], a[4:7], v[84:87]
  v_mfma_f32_16x16x32_bf16 v[84:87], a[40:43], a[8:11], v[84:87]
  v_mfma_f32_16x16x32_bf16 v[84:87], a[44:47], a[12:15], v[84:87]
  v_mfma_f32_16x16x32_bf16 v[84:87], a[48:51], a[16:19], v[84:87]
  v_mfma_f32_16x16x32_bf16 v[84:87], a[52:55], a[20:23], v[84:87]
  v_mfma_f32_16x16x32_bf16 v[84:87], a[56:59], a[24:27], v[84:87]
  v_mfma_f32_16x16x32_bf16 v[84:87], a[60:63], a[28:31], v[84:87]
  s_sub_u32 s73, s56, 2
  s_cmp_ge_u32 s65, s73
  s_cbranch_scc1 L_klate
  s_waitcnt vmcnt(24)
L_krd:
  ds_read_b128 a[32:35], v72
  ds_read_b128 a[36:39], v73
  ds_read_b128 a[40:43], v74
  ds_read_b128 a[44:47], v75
  ds_read_b128 a[48:51], v72 offset:256
  ds_read_b128 a[52:55], v73 offset:256
  ds_read_b128 a[56:59], v74 offset:256
  ds_read_b128 a[60:63], v75 offset:256
  s_waitcnt lgkmcnt(0)
  s_sub_u32 s73, s56, 3
  s_cmp_ge_u32 s65, s73
  s_cbranch_scc1 L_kdone
  v_readfirstlane_b32 s74, v108
  s_nop 3
  s_cmp_ge_u32 s74, s55
  s_cbranch_scc1 L_limchk
L_tileok:
  s_xor_b32 s74, s74, s59
  s_lshr_b32 s75, s74, 2
  s_lshl_b32 s75, s75, 15
  s_and_b32 s76, s74, 1
  s_lshl_b32 s76, s76, 11
  s_lshr_b32 s74, s74, 1
  s_and_b32 s74, s74, 1
  s_lshl_b32 s74, s74, 12
  s_or_b32 s74, s74, s76
  s_add_u32 s60, s58, s75
  s_add_u32 s60, s60, s74
  s_mov_b32 m0, s63
  s_add_u32 s72, s60, 16384
  buffer_load_dwordx4 v68, s[8:11], s60 offen nt lds
  buffer_load_dwordx4 v69, s[8:11], s60 offen offset:1024 nt lds
  buffer_load_dwordx4 v70, s[8:11], s60 offen offset:2048 nt lds
  buffer_load_dwordx4 v71, s[8:11], s60 offen offset:3072 nt lds
  s_add_u32 m0, s63, 4096
  s_nop 0
  buffer_load_dwordx4 v68, s[8:11], s72 offen nt lds
  buffer_load_dwordx4 v69, s[8:11], s72 offen offset:1024 nt lds
  buffer_load_dwordx4 v70, s[8:11], s72 offen offset:2048 nt lds
  buffer_load_dwordx4 v71, s[8:11], s72 offen offset:3072 nt lds
  s_xor_b32 s63, s63, 8192
L_kdone:
  v_xor_b32 v72, 8192, v72
  v_xor_b32 v73, 8192, v73
  v_xor_b32 v74, 8192, v74
  v_xor_b32 v75, 8192, v75
L_soft:
  v_cvt_pk_bf16_f32 v94, v84, v85
  v_cvt_pk_bf16_f32 v95, v86, v87
  v_lshlrev_b32 v84, 16, v94
  v_and_b32 v85, 0xffff0000, v94
  v_lshlrev_b32 v86, 16, v95
  v_and_b32 v87, 0xffff0000, v95
  v_max3_f32 v94, v84, v85, v86
  v_max_f32 v94, v94, v87
  v_mov_b32 v95, v94
  s_nop 1
  v_permlane32_swap_b32 v95, v94
  v_max_f32 v94, v94, v95
  v_mov_b32 v95, v94
  s_nop 1
  v_permlane16_swap_b32 v95, v94
  v_max3_f32 v94, v94, v95, v90
  v_sub_f32 v95, v90, v94
  v_mul_f32 v95, s66, v95
  v_mul_f32 v96, s67, v94
  v_exp_f32 v92, v95
  v_mov_b32 v90, v94
  v_fma_f32 v84, v84, s66, v96
  v_fma_f32 v85, v85, s66, v96
  v_fma_f32 v86, v86, s66, v96
  v_fma_f32 v87, v87, s66, v96
  v_exp_f32 v84, v84
  v_exp_f32 v85, v85
  v_exp_f32 v86, v86
  v_exp_f32 v87, v87
  v_cmp_neq_f32 vcc, 1.0, v92
  v_add_f32 v94, v84, v85
  v_add_f32 v95, v86, v87
  v_cvt_pk_bf16_f32 v88, v84, v85
  v_cvt_pk_bf16_f32 v89, v86, v87
  v_add_f32 v94, v94, v95
  v_fma_f32 v91, v91, v92, v94
  s_cbranch_vccz L_noresc
  v_pk_mul_f32 v[0:1], v[0:1], v[92:93] op_sel_hi:[1,0]
  v_pk_mul_f32 v[2:3], v[2:3], v[92:93] op_sel_hi:[1,0]
  v_pk_mul_f32 v[4:5], v[4:5], v[92:93] op_sel_hi:[1,0]
  v_pk_mul_f32 v[6:7], v[6:7], v[92:93] op_sel_hi:[1,0]
  v_pk_mul_f32 v[8:9], v[8:9], v[92:93] op_sel_hi:[1,0]
  v_pk_mul_f32 v[10:11], v[10:11], v[92:93] op_sel_hi:[1,0]
  v_pk_mul_f32 v[12:13], v[12:13], v[92:93] op_sel_hi:[1,0]
  v_pk_mul_f32 v[14:15], v[14:15], v[92:93] op_sel_hi:[1,0]
  v_pk_mul_f32 v[16:17], v[16:17], v[92:93] op_sel_hi:[1,0]
  v_pk_mul_f32 v[18:19], v[18:19], v[92:93] op_sel_hi:[1,0]
  v_pk_mul_f32 v[20:21], v[20:21], v[92:93] op_sel_hi:[1,0]
  v_pk_mul_f32 v[22:23], v[22:23], v[92:93] op_sel_hi:[1,0]
  v_pk_mul_f32 v[24:25], v[24:25], v[92:93] op_sel_hi:[1,0]
  v_pk_mul_f32 v[26:27], v[26:27], v[92:93] op_sel_hi:[1,0]
  v_pk_mul_f32 v[28:29], v[28:29], v[92:93] op_sel_hi:[1,0]
  v_pk_mul_f32 v[30:31], v[30:31], v[92:93] op_sel_hi:[1,0]
  v_pk_mul_f32 v[32:33], v[32:33], v[92:93] op_sel_hi:[1,0]
  v_pk_mul_f32 v[34:35], v[34:35], v[92:93] op_sel_hi:[1,0]
  v_pk_mul_f32 v[36:37], v[36:37], v[92:93] op_sel_hi:[1,0]
  v_pk_mul_f32 v[38:39], v[38:39], v[92:93] op_sel_hi:[1,0]
  v_pk_mul_f32 v[40:41], v[40:41], v[92:93] op_sel_hi:[1,0]
  v_pk_mul_f32 v[42:43], v[42:43], v[92:93] op_sel_hi:[1,0]
  v_pk_mul_f32 v[44:45], v[44:45], v[92:93] op_sel_hi:[1,0]
  v_pk_mul_f32 v[46:47], v[46:47], v[92:93] op_sel_hi:[1,0]
  v_pk_mul_f32 v[48:49], v[48:49], v[92:93] op_sel_hi:[1,0]
  v_pk_mul_f32 v[50:51], v[50:51], v[92:93] op_sel_hi:[1,0]
  v_pk_mul_f32 v[52:53], v[52:53], v[92:93] op_sel_hi:[1,0]
  v_pk_mul_f32 v[54:55], v[54:55], v[92:93] op_sel_hi:[1,0]
  v_pk_mul_f32 v[56:57], v[56:57], v[92:93] op_sel_hi:[1,0]
  v_pk_mul_f32 v[58:59], v[58:59], v[92:93] op_sel_hi:[1,0]
  v_pk_mul_f32 v[60:61], v[60:61], v[92:93] op_sel_hi:[1,0]
  v_pk_mul_f32 v[62:63], v[62:63], v[92:93] op_sel_hi:[1,0]
L_noresc:
  s_sub_u32 s73, s56, 1
  s_cmp_eq_u32 s65, s73
  s_cbranch_scc1 L_vjit
L_pv:
  v_mfma_f32_16x16x16_bf16 v[0:3], a[64:65], v[88:89], v[0:3]
  v_mfma_f32_16x16x16_bf16 v[4:7], a[66:67], v[88:89], v[4:7]
  v_mfma_f32_16x16x16_bf16 v[8:11], a[68:69], v[88:89], v[8:11]
  v_mfma_f32_16x16x16_bf16 v[12:15], a[70:71], v[88:89], v[12:15]
  v_mfma_f32_16x16x16_bf16 v[16:19], a[72:73], v[88:89], v[16:19]
  v_mfma_f32_16x16x16_bf16 v[20:23], a[74:75], v[88:89], v[20:23]
  v_mfma_f32_16x16x16_bf16 v[24:27], a[76:77], v[88:89], v[24:27]
  v_mfma_f32_16x16x16_bf16 v[28:31], a[78:79], v[88:89], v[28:31]
  v_mfma_f32_16x16x16_bf16 v[32:35], a[80:81], v[88:89], v[32:35]
  v_mfma_f32_16x16x16_bf16 v[36:39], a[82:83], v[88:89], v[36:39]
  v_mfma_f32_16x16x16_bf16 v[40:43], a[84:85], v[88:89], v[40:43]
  v_mfma_f32_16x16x16_bf16 v[44:47], a[86:87], v[88:89], v[44:47]
  v_mfma_f32_16x16x16_bf16 v[48:51], a[88:89], v[88:89], v[48:51]
  v_mfma_f32_16x16x16_bf16 v[52:55], a[90:91], v[88:89], v[52:55]
  v_mfma_f32_16x16x16_bf16 v[56:59], a[92:93], v[88:89], v[56:59]
  v_mfma_f32_16x16x16_bf16 v[60:63], a[94:95], v[88:89], v[60:63]
  s_sub_u32 s73, s56, 3
  s_cmp_ge_u32 s65, s73
  s_cbranch_scc1 L_vlate
  s_waitcnt vmcnt(24)
  ds_read_b64_tr_b16 a[64:65], v76
  ds_read_b64_tr_b16 a[66:67], v77
  ds_read_b64_tr_b16 a[68:69], v78
  ds_read_b64_tr_b16 a[70:71], v79
  ds_read_b64_tr_b16 a[72:73], v80
  ds_read_b64_tr_b16 a[74:75], v81
  ds_read_b64_tr_b16 a[76:77], v82
  ds_read_b64_tr_b16 a[78:79], v83
  ds_read_b64_tr_b16 a[80:81], v76 offset:256
  ds_read_b64_tr_b16 a[82:83], v77 offset:256
  ds_read_b64_tr_b16 a[84:85], v78 offset:256
  ds_read_b64_tr_b16 a[86:87], v79 offset:256
  ds_read_b64_tr_b16 a[88:89], v80 offset:256
  ds_read_b64_tr_b16 a[90:91], v81 offset:256
  ds_read_b64_tr_b16 a[92:93], v82 offset:256
  ds_read_b64_tr_b16 a[94:95], v83 offset:256
  s_waitcnt lgkmcnt(0)
  s_mov_b32 m0, s64
  s_add_u32 s72, s60, 16384
  buffer_load_dwordx4 v68, s[12:15], s60 offen nt lds
  buffer_load_dwordx4 v69, s[12:15], s60 offen offset:1024 nt lds
  buffer_load_dwordx4 v70, s[12:15], s60 offen offset:2048 nt lds
  buffer_load_dwordx4 v71, s[12:15], s60 offen offset:3072 nt lds
  s_add_u32 m0, s64, 4096
  s_nop 0
  buffer_load_dwordx4 v68, s[12:15], s72 offen nt lds
  buffer_load_dwordx4 v69, s[12:15], s72 offen offset:1024 nt lds
  buffer_load_dwordx4 v70, s[12:15], s72 offen offset:2048 nt lds
  buffer_load_dwordx4 v71, s[12:15], s72 offen offset:3072 nt lds
  s_xor_b32 s64, s64, 8192
L_vdone:
  v_xor_b32 v76, 8192, v76
  v_xor_b32 v77, 8192, v77
  v_xor_b32 v78, 8192, v78
  v_xor_b32 v79, 8192, v79
  v_xor_b32 v80, 8192, v80
  v_xor_b32 v81, 8192, v81
  v_xor_b32 v82, 8192, v82
  v_xor_b32 v83, 8192, v83
L_next:
  s_add_u32 s65, s65, 1
  s_cmp_lt_u32 s65, s56
  s_cbranch_scc1 L_loop
  s_branch L_tail
L_klate:
  s_sub_u32 s73, s56, 1
  s_cmp_eq_u32 s65, s73
  s_cbranch_scc1 L_k31
  s_waitcnt vmcnt(8)
  s_branch L_krd
L_k31:
  s_nop 7
  s_branch L_soft
L_vlate:
  s_sub_u32 s73, s56, 3
  s_cmp_eq_u32 s65, s73
  s_cbranch_scc0 L_next
  s_waitcnt vmcnt(16)
  ds_read_b64_tr_b16 a[64:65], v76
  ds_read_b64_tr_b16 a[66:67], v77
  ds_read_b64_tr_b16 a[68:69], v78
  ds_read_b64_tr_b16 a[70:71], v79
  ds_read_b64_tr_b16 a[72:73], v80
  ds_read_b64_tr_b16 a[74:75], v81
  ds_read_b64_tr_b16 a[76:77], v82
  ds_read_b64_tr_b16 a[78:79], v83
  ds_read_b64_tr_b16 a[80:81], v76 offset:256
  ds_read_b64_tr_b16 a[82:83], v77 offset:256
  ds_read_b64_tr_b16 a[84:85], v78 offset:256
  ds_read_b64_tr_b16 a[86:87], v79 offset:256
  ds_read_b64_tr_b16 a[88:89], v80 offset:256
  ds_read_b64_tr_b16 a[90:91], v81 offset:256
  ds_read_b64_tr_b16 a[92:93], v82 offset:256
  ds_read_b64_tr_b16 a[94:95], v83 offset:256
  s_waitcnt lgkmcnt(0)
  s_branch L_vdone
L_vjit:
  s_waitcnt vmcnt(0)
  ds_read_b64_tr_b16 a[64:65], v76
  ds_read_b64_tr_b16 a[66:67], v77
  ds_read_b64_tr_b16 a[68:69], v78
  ds_read_b64_tr_b16 a[70:71], v79
  ds_read_b64_tr_b16 a[72:73], v80
  ds_read_b64_tr_b16 a[74:75], v81
  ds_read_b64_tr_b16 a[76:77], v82
  ds_read_b64_tr_b16 a[78:79], v83
  ds_read_b64_tr_b16 a[80:81], v76 offset:256
  ds_read_b64_tr_b16 a[82:83], v77 offset:256
  ds_read_b64_tr_b16 a[84:85], v78 offset:256
  ds_read_b64_tr_b16 a[86:87], v79 offset:256
  ds_read_b64_tr_b16 a[88:89], v80 offset:256
  ds_read_b64_tr_b16 a[90:91], v81 offset:256
  ds_read_b64_tr_b16 a[92:93], v82 offset:256
  ds_read_b64_tr_b16 a[94:95], v83 offset:256
  s_waitcnt lgkmcnt(0)
  s_branch L_pv
L_limchk:
  s_mov_b32 s81, 262144
  v_mov_b32 v94, 136652
L_limchk1:
  ds_read2_b32 v[96:97], v94 offset0:0 offset1:1
  s_waitcnt lgkmcnt(0)
  v_readfirstlane_b32 s75, v97
  v_readfirstlane_b32 s76, v96
  s_nop 3
  s_mov_b32 s55, s76
  s_cmp_lt_u32 s74, s76
  s_cbranch_scc1 L_tileok
  s_cmp_lg_u32 s75, 0
  s_cbranch_scc1 L_limfin
  s_sleep 2
  s_sub_u32 s81, s81, 1
  s_cmp_lg_u32 s81, 0
  s_cbranch_scc1 L_limchk1
L_limfin:
  s_add_u32 s56, s65, 3
  s_branch L_kdone
L_tail:
  v_mov_b32 v95, v91
  s_nop 1
  v_permlane32_swap_b32 v95, v91
  v_add_f32 v91, v91, v95
  v_mov_b32 v95, v91
  s_nop 1
  v_permlane16_swap_b32 v95, v91
  v_add_f32 v91, v91, v95
  s_movk_i32 s73, 1040
  v_mul_lo_u32 v105, v65, s73
  v_lshl_add_u32 v105, v66, 4, v105
  v_add_u32 v105, s62, v105
  s_lshl_b32 s72, s3, 6
  s_add_u32 s72, s72, 135296
  v_lshlrev_b32 v96, 3, v65
  v_add_u32 v96, s72, v96
  s_mov_b32 exec_lo, 0x00ff00ff
  s_mov_b32 exec_hi, 0x00ff00ff
  ds_write_b128 v105, v[0:3]
  ds_write_b128 v105, v[4:7] offset:64
  ds_write_b128 v105, v[8:11] offset:128
  ds_write_b128 v105, v[12:15] offset:192
  ds_write_b128 v105, v[16:19] offset:256
  ds_write_b128 v105, v[20:23] offset:320
  ds_write_b128 v105, v[24:27] offset:384
  ds_write_b128 v105, v[28:31] offset:448
  ds_write_b128 v105, v[32:35] offset:512
  ds_write_b128 v105, v[36:39] offset:576
  ds_write_b128 v105, v[40:43] offset:640
  ds_write_b128 v105, v[44:47] offset:704
  ds_write_b128 v105, v[48:51] offset:768
  ds_write_b128 v105, v[52:55] offset:832
  ds_write_b128 v105, v[56:59] offset:896
  ds_write_b128 v105, v[60:63] offset:960
  s_mov_b64 exec, 0xff
  ds_write_b64 v96, v[90:91]
  s_mov_b64 exec, -1
  v_and_b32 v94, 3, v64
  v_lshrrev_b32 v95, 2, v64
  s_lshr_b32 s72, s3, 1
  s_lshl_b32 s72, s72, 2
  v_add_u32 v94, s72, v94
  v_mul_lo_u32 v106, v94, s73
  v_lshl_add_u32 v106, v95, 5, v106
  s_and_b32 s72, s3, 1
  s_lshl_b32 s72, s72, 9
  v_add_u32 v106, s72, v106
  v_add_u32 v107, 65536, v106
  v_lshlrev_b32 v96, 3, v94
  v_add_u32 v96, 135296, v96
  s_waitcnt lgkmcnt(0)
  s_barrier
  ds_read_b64 v[0:1], v96 offset:0
  ds_read_b64 v[2:3], v96 offset:64
  ds_read_b64 v[4:5], v96 offset:128
  ds_read_b64 v[6:7], v96 offset:192
  ds_read_b128 v[8:11], v106
  ds_read_b128 v[12:15], v106 offset:16
  ds_read_b128 v[16:19], v106 offset:32768
  ds_read_b128 v[20:23], v106 offset:32784
  ds_read_b128 v[24:27], v107
  ds_read_b128 v[28:31], v107 offset:16
  ds_read_b128 v[32:35], v107 offset:32768
  ds_read_b128 v[36:39], v107 offset:32784
  s_waitcnt lgkmcnt(8)
  v_max3_f32 v40, v0, v2, v4
  v_max_f32 v40, v40, v6
  v_sub_f32 v44, v0, v40
  v_sub_f32 v45, v2, v40
  v_sub_f32 v46, v4, v40
  v_sub_f32 v47, v6, v40
  v_mul_f32 v44, s66, v44
  v_mul_f32 v45, s66, v45
  v_mul_f32 v46, s66, v46
  v_mul_f32 v47, s66, v47
  v_exp_f32 v44, v44
  v_exp_f32 v45, v45
  v_exp_f32 v46, v46
  v_exp_f32 v47, v47
  s_nop 0
  v_mul_f32 v41, v44, v1
  v_fmac_f32 v41, v45, v3
  v_fmac_f32 v41, v46, v5
  v_fmac_f32 v41, v47, v7
  s_waitcnt lgkmcnt(0)
  v_mul_f32 v48, v44, v8
  v_mul_f32 v49, v44, v9
  v_mul_f32 v50, v44, v10
  v_mul_f32 v51, v44, v11
  v_mul_f32 v52, v44, v12
  v_mul_f32 v53, v44, v13
  v_mul_f32 v54, v44, v14
  v_mul_f32 v55, v44, v15
  v_fmac_f32 v48, v45, v16
  v_fmac_f32 v49, v45, v17
  v_fmac_f32 v50, v45, v18
  v_fmac_f32 v51, v45, v19
  v_fmac_f32 v52, v45, v20
  v_fmac_f32 v53, v45, v21
  v_fmac_f32 v54, v45, v22
  v_fmac_f32 v55, v45, v23
  v_fmac_f32 v48, v46, v24
  v_fmac_f32 v49, v46, v25
  v_fmac_f32 v50, v46, v26
  v_fmac_f32 v51, v46, v27
  v_fmac_f32 v52, v46, v28
  v_fmac_f32 v53, v46, v29
  v_fmac_f32 v54, v46, v30
  v_fmac_f32 v55, v46, v31
  v_fmac_f32 v48, v47, v32
  v_fmac_f32 v49, v47, v33
  v_fmac_f32 v50, v47, v34
  v_fmac_f32 v51, v47, v35
  v_fmac_f32 v52, v47, v36
  v_fmac_f32 v53, v47, v37
  v_fmac_f32 v54, v47, v38
  v_fmac_f32 v55, v47, v39
  buffer_store_dwordx4 v[48:51], v104, s[28:31], s70 offen sc1
  buffer_store_dwordx4 v[52:55], v104, s[28:31], s70 offen offset:1024 sc1
  v_lshlrev_b32 v94, 3, v64
  s_mov_b64 exec, 0xf
  buffer_store_dwordx2 v[40:41], v94, s[28:31], s70 offen offset:2048 sc1
  s_mov_b64 exec, -1
  s_branch L_fin
L_helper:
  s_setprio 3
  v_lshrrev_b32 v94, 1, v64
  v_lshlrev_b32 v94, 13, v94
  v_and_b32 v95, 1, v64
  v_lshl_add_u32 v94, v95, 4, v94
  s_mov_b32 s65, s80
  s_lshl_b32 s72, s4, 10
  s_lshl_b32 s73, s65, 5
  s_add_u32 s72, s72, s73
  v_add_u32 v68, s72, v94
  s_movk_i32 s73, 896
  v_mul_lo_u32 v69, v65, s73
  v_lshl_add_u32 v69, v66, 4, v69
  s_lshl_b32 s62, s7, 12
  s_add_u32 s62, s62, 136704
  v_mov_b32 v96, 136640
  v_mov_b32 v98, 0
  v_mov_b32 v99, 0
  v_mov_b32 v100, 0
  v_mov_b32 v101, 0
  ds_write_b128 v96, v[98:101] offset:16
  s_and_b32 s75, s5, 1
  s_mul_i32 s75, s75, -20
  s_add_u32 s75, s75, 116
  v_mov_b32 v100, 12
  v_mov_b32 v101, s75
  ds_write_b128 v96, v[98:101]
  s_waitcnt lgkmcnt(0)
  s_add_u32 s56, s46, 0x790000
  s_addc_u32 s57, s47, 0
  s_load_dwordx2 s[60:61], s[56:57], 0
  s_mov_b32 s16, s38
  s_and_b32 s17, s39, 0xffff
  s_mov_b32 s18, 0x380000
  s_mov_b32 s19, 0x20000
  s_mov_b32 s20, s32
  s_and_b32 s21, s33, 0xffff
  s_mov_b32 s22, 0x7000
  s_mov_b32 s23, 0x20000
  s_lshl_b32 s74, s7, 18
  s_lshl_b32 s75, s7, 6
  s_add_u32 m0, s62, 0
  s_add_u32 s76, s75, 14336
  buffer_load_dwordx4 v68, s[16:19], s74 offen lds
  buffer_load_dwordx4 v[0:3], v69, s[20:23], s75 offen
  buffer_load_dwordx4 v[4:7], v69, s[20:23], s76 offen
  s_add_u32 s74, s74, 1048576
  s_add_u32 s75, s75, 256
  s_add_u32 m0, s62, 1024
  s_add_u32 s76, s75, 14336
  buffer_load_dwordx4 v68, s[16:19], s74 offen lds
  buffer_load_dwordx4 v[8:11], v69, s[20:23], s75 offen
  buffer_load_dwordx4 v[12:15], v69, s[20:23], s76 offen
  s_add_u32 s74, s74, 1048576
  s_add_u32 s75, s75, 256
  s_add_u32 m0, s62, 2048
  s_add_u32 s76, s75, 14336
  buffer_load_dwordx4 v68, s[16:19], s74 offen lds
  buffer_load_dwordx4 v[16:19], v69, s[20:23], s75 offen
  buffer_load_dwordx4 v[20:23], v69, s[20:23], s76 offen
  s_add_u32 s74, s74, 1048576
  s_add_u32 s75, s75, 256
  s_cmp_ge_u32 s7, 2
  s_cbranch_scc1 L_hq_issued
  s_add_u32 m0, s62, 3072
  s_add_u32 s76, s75, 14336
  buffer_load_dwordx4 v68, s[16:19], s74 offen lds
  buffer_load_dwordx4 v[24:27], v69, s[20:23], s75 offen
  buffer_load_dwordx4 v[28:31], v69, s[20:23], s76 offen
L_hq_issued:
  s_barrier
  s_mov_b32 s28, s46
  s_and_b32 s29, s47, 0xffff
  s_mov_b32 s30, 0x1000000
  s_mov_b32 s31, 0x20000
  s_mov_b32 s24, s40
  s_and_b32 s25, s41, 0xffff
  s_mov_b32 s26, 0x380000
  s_mov_b32 s27, 0x20000
  s_mov_b32 s34, s42
  s_mov_b32 s35, s43
  v_lshrrev_b32 v94, 2, v65
  v_lshl_add_u32 v94, v66, 3, v94
  v_lshlrev_b32 v94, 5, v94
  v_and_b32 v95, 3, v65
  v_lshl_add_u32 v94, v95, 3, v94
  v_add_u32 v94, s62, v94
  v_mov_b32 v48, 0
  v_mov_b32 v49, 0
  v_mov_b32 v50, 0
  v_mov_b32 v51, 0
  v_mov_b32 v52, 0
  v_mov_b32 v53, 0
  v_mov_b32 v54, 0
  v_mov_b32 v55, 0
  s_lshl_b32 s72, s7, 11
  s_add_u32 s72, s72, 153088
  v_lshlrev_b32 v96, 6, v65
  v_lshl_add_u32 v96, v66, 4, v96
  v_add_u32 v96, s72, v96
  s_waitcnt vmcnt(0)
  ds_read_b64_tr_b16 v[32:33], v94 offset:0
  ds_read_b64_tr_b16 v[34:35], v94 offset:128
  s_waitcnt lgkmcnt(0)
  v_mfma_f32_16x16x32_bf16 v[48:51], v[32:35], v[0:3], v[48:51]
  v_mfma_f32_16x16x32_bf16 v[52:55], v[32:35], v[4:7], v[52:55]
  ds_read_b64_tr_b16 v[36:37], v94 offset:1024
  ds_read_b64_tr_b16 v[38:39], v94 offset:1152
  s_waitcnt lgkmcnt(0)
  v_mfma_f32_16x16x32_bf16 v[48:51], v[36:39], v[8:11], v[48:51]
  v_mfma_f32_16x16x32_bf16 v[52:55], v[36:39], v[12:15], v[52:55]
  ds_read_b64_tr_b16 v[40:41], v94 offset:2048
  ds_read_b64_tr_b16 v[42:43], v94 offset:2176
  s_waitcnt lgkmcnt(0)
  v_mfma_f32_16x16x32_bf16 v[48:51], v[40:43], v[16:19], v[48:51]
  v_mfma_f32_16x16x32_bf16 v[52:55], v[40:43], v[20:23], v[52:55]
  s_cmp_ge_u32 s7, 2
  s_cbranch_scc1 L_hq_mm
  ds_read_b64_tr_b16 v[44:45], v94 offset:3072
  ds_read_b64_tr_b16 v[46:47], v94 offset:3200
  s_waitcnt lgkmcnt(0)
  v_mfma_f32_16x16x32_bf16 v[48:51], v[44:47], v[24:27], v[48:51]
  v_mfma_f32_16x16x32_bf16 v[52:55], v[44:47], v[28:31], v[52:55]
L_hq_mm:
  s_nop 7
  ds_write_b128 v96, v[48:51]
  ds_write_b128 v96, v[52:55] offset:1024
  v_mov_b32 v97, 136640
  v_mov_b32 v98, 1
  s_waitcnt lgkmcnt(0)
  s_mov_b64 exec, 1
  ds_add_u32 v97, v98
  s_mov_b64 exec, -1
  v_lshrrev_b32 v94, 3, v64
  s_lshl_b32 s72, s7, 3
  v_add_u32 v94, s72, v94
  v_and_b32 v95, 7, v64
  v_lshlrev_b32 v96, 6, v94
  v_lshl_add_u32 v96, v95, 3, v96
  v_add_u32 v96, 153088, v96
  s_add_u32 s60, s60, 0x7f4a7c15
  s_addc_u32 s61, s61, 0x9e3779b9
  s_lshl_b32 s59, s60, 16
  s_lshr_b32 s82, s60, 16
  s_lshl_b32 s73, s61, 16
  s_or_b32 s82, s82, s73
  v_lshrrev_b32 v98, 2, v94
  v_lshlrev_b32 v98, 14, v98
  v_and_b32 v99, 3, v94
  v_lshl_add_u32 v98, v99, 7, v98
  v_lshl_add_u32 v98, v95, 4, v98
  s_lshl_b32 s72, s4, 17
  s_lshl_b32 s73, s65, 9
  s_add_u32 s72, s72, s73
  s_add_u32 s72, s72, 0x600000
  s_mov_b32 s81, 262144
L_hs1:
  ds_read_b32 v100, v97
  s_waitcnt lgkmcnt(0)
  v_readfirstlane_b32 s73, v100
  s_nop 3
  s_cmp_ge_u32 s73, 4
  s_cbranch_scc1 L_hs1ok
  s_sub_u32 s81, s81, 1
  s_cmp_lg_u32 s81, 0
  s_cbranch_scc1 L_hs1
L_hs1ok:
  ds_read_b64 v[0:1], v96 offset:0
  ds_read_b64 v[2:3], v96 offset:2048
  ds_read_b64 v[4:5], v96 offset:4096
  ds_read_b64 v[6:7], v96 offset:6144
  s_waitcnt lgkmcnt(0)
  v_add_f32 v0, v0, v2
  v_add_f32 v1, v1, v3
  v_add_f32 v4, v4, v6
  v_add_f32 v5, v5, v7
  v_add_f32 v0, v0, v4
  v_add_f32 v1, v1, v5
  v_cvt_pk_bf16_f32 v0, v0, v1
  v_and_b32 v4, 0xffff, v0
  v_lshrrev_b32 v6, 16, v0
  v_or_b32 v4, s59, v4
  v_or_b32 v6, s59, v6
  v_mov_b32 v5, s82
  v_mov_b32 v7, s82
  buffer_store_dwordx4 v[4:7], v98, s[28:31], s72 offen sc1
  v_lshlrev_b32 v104, 4, v64
  s_lshl_b32 s72, s4, 3
  s_add_u32 s72, s72, s6
  s_lshl_b32 s72, s72, 14
  s_lshl_b32 s73, s7, 12
  s_add_u32 s72, s72, s73
  s_add_u32 s72, s72, 0x600000
  v_bfe_u32 v94, v64, 3, 2
  s_lshr_b32 s73, s7, 1
  s_lshl_b32 s73, s73, 2
  v_add_u32 v94, s73, v94
  s_movk_i32 s73, 528
  v_mul_lo_u32 v94, v94, s73
  v_lshrrev_b32 v95, 5, v64
  v_lshl_add_u32 v94, v95, 5, v94
  v_and_b32 v95, 7, v64
  v_lshl_add_u32 v94, v95, 2, v94
  s_and_b32 s73, s7, 1
  s_lshl_b32 s73, s73, 8
  s_add_u32 s73, s73, 131072
  v_add_u32 v94, s73, v94
  s_mov_b32 s81, 262144
  s_mov_b32 s74, 0xffff0000
  s_mov_b32 s75, 0x05040100
  s_waitcnt vmcnt(0)
L_hq_poll:
  buffer_load_dwordx4 v[8:11], v104, s[28:31], s72 offen sc1
  buffer_load_dwordx4 v[12:15], v104, s[28:31], s72 offen offset:1024 sc1
  buffer_load_dwordx4 v[16:19], v104, s[28:31], s72 offen offset:2048 sc1
  buffer_load_dwordx4 v[20:23], v104, s[28:31], s72 offen offset:3072 sc1
  s_waitcnt vmcnt(0)
  v_and_b32 v24, s74, v8
  v_and_b32 v25, s74, v10
  v_xor_b32 v24, s59, v24
  v_xor_b32 v25, s59, v25
  v_xor_b32 v32, s82, v9
  v_xor_b32 v33, s82, v11
  v_and_b32 v26, s74, v12
  v_and_b32 v27, s74, v14
  v_xor_b32 v26, s59, v26
  v_xor_b32 v27, s59, v27
  v_xor_b32 v34, s82, v13
  v_xor_b32 v35, s82, v15
  v_and_b32 v28, s74, v16
  v_and_b32 v29, s74, v18
  v_xor_b32 v28, s59, v28
  v_xor_b32 v29, s59, v29
  v_xor_b32 v36, s82, v17
  v_xor_b32 v37, s82, v19
  v_and_b32 v30, s74, v20
  v_and_b32 v31, s74, v22
  v_xor_b32 v30, s59, v30
  v_xor_b32 v31, s59, v31
  v_xor_b32 v38, s82, v21
  v_xor_b32 v39, s82, v23
  v_or3_b32 v24, v24, v25, v26
  v_or3_b32 v27, v27, v28, v29
  v_or3_b32 v30, v30, v31, v32
  v_or3_b32 v33, v33, v34, v35
  v_or3_b32 v36, v36, v37, v38
  v_or3_b32 v24, v24, v27, v30
  v_or3_b32 v33, v33, v36, v39
  v_or_b32 v24, v24, v33
  v_cmp_ne_u32 vcc, 0, v24
  s_nop 1
  s_cbranch_vccz L_hq_ok
  s_sub_u32 s81, s81, 1
  s_cmp_lg_u32 s81, 0
  s_cbranch_scc1 L_hq_poll
L_hq_ok:
  v_perm_b32 v24, v10, v8, s75
  v_perm_b32 v25, v14, v12, s75
  v_perm_b32 v26, v18, v16, s75
  v_perm_b32 v27, v22, v20, s75
  ds_write_b32 v94, v24
  ds_write_b32 v94, v25 offset:64
  ds_write_b32 v94, v26 offset:128
  ds_write_b32 v94, v27 offset:192
  s_waitcnt lgkmcnt(0)
L_hq_done:
  s_barrier
  s_mov_b32 s48, s34
  s_and_b32 s49, s35, 0xffff
  s_mov_b32 s50, 0x7000
  s_mov_b32 s51, 0x20000
  s_lshl_b32 s72, s69, 7
  s_lshl_b32 s73, s6, 4
  s_add_u32 s72, s72, s73
  s_mul_i32 s72, s72, 896
  s_lshl_b32 s73, s7, 12
  s_add_u32 s72, s72, s73
  buffer_load_dwordx4 v[8:11], v104, s[24:27], s72 offen
  buffer_load_dwordx4 v[12:15], v104, s[24:27], s72 offen offset:1024
  buffer_load_dwordx4 v[16:19], v104, s[24:27], s72 offen offset:2048
  buffer_load_dwordx4 v[20:23], v104, s[24:27], s72 offen offset:3072
  s_lshl_b32 s72, s68, 2
  s_add_u32 s72, s72, s7
  s_lshl_b32 s72, s72, 2
  s_add_u32 s72, s72, s5
  s_mul_i32 s70, s72, 2176
  s_lshl_b32 s72, s6, 5
  s_add_u32 s72, s72, s69
  s_lshl_b32 s72, s72, 13
  s_lshl_b32 s73, s7, 11
  s_add_u32 s71, s72, s73
  s_add_u32 s71, s71, 0x400000
  v_mov_b32 v0, -1
  v_mov_b32 v1, -1
  v_mov_b32 v2, -1
  v_mov_b32 v3, -1
  buffer_store_dwordx4 v[0:3], v104, s[28:31], s70 offen sc1
  buffer_store_dwordx4 v[0:3], v104, s[28:31], s70 offen offset:1024 sc1
  buffer_store_dwordx4 v[0:3], v104, s[28:31], s71 offen sc1
  buffer_store_dwordx4 v[0:3], v104, s[28:31], s71 offen offset:1024 sc1
  s_mov_b64 exec, 0xff
  buffer_store_dwordx4 v[0:3], v104, s[28:31], s70 offen offset:2048 sc1
  s_mov_b64 exec, -1
  s_waitcnt vmcnt(0)
  v_mov_b32 v98, 1
  v_mov_b32 v97, 136644
  s_mov_b64 exec, 1
  ds_add_rtn_u32 v100, v97, v98
  s_waitcnt lgkmcnt(0)
  v_readfirstlane_b32 s73, v100
  s_nop 3
  s_mov_b64 exec, -1
  s_cmp_eq_u32 s73, 3
  s_cbranch_scc0 L_hnoflag2
  v_lshrrev_b32 v99, 2, v64
  v_and_b32 v100, 3, v64
  v_lshl_add_u32 v99, v100, 3, v99
  v_lshlrev_b32 v99, 7, v99
  v_mov_b32 v98, s82
  s_lshl_b32 s76, s6, 12
  s_lshl_b32 s77, s69, 2
  s_add_u32 s76, s76, s77
  s_add_u32 s76, s76, 0x760000
  s_mov_b32 exec_lo, -1
  s_mov_b32 exec_hi, 0
  buffer_store_dword v98, v99, s[28:31], s76 offen sc1
L_hnoflag2:
  s_mov_b64 exec, -1
  s_mov_b32 s78, 0x05040100
  s_mov_b32 s79, 0x07060302
  s_lshl_b32 s72, s69, 7
  v_lshlrev_b32 v94, 3, v66
  v_add_u32 v94, s72, v94
  s_movk_i32 s73, 896
  v_mul_lo_u32 v94, v94, s73
  s_mul_i32 s72, s7, 256
  v_lshl_add_u32 v94, v65, 4, v94
  v_add_u32 v94, s72, v94
  v_mov_b32 v0, 0
  v_mov_b32 v1, 0
  v_mov_b32 v2, 0
  v_mov_b32 v3, 0
  v_mov_b32 v4, 0
  v_mov_b32 v5, 0
  v_mov_b32 v6, 0
  v_mov_b32 v7, 0
  v_mov_b32 v8, 0
  v_mov_b32 v9, 0
  v_mov_b32 v10, 0
  v_mov_b32 v11, 0
  v_mov_b32 v12, 0
  v_mov_b32 v13, 0
  v_mov_b32 v14, 0
  v_mov_b32 v15, 0
  v_mov_b32 v16, 0
  v_mov_b32 v17, 0
  v_mov_b32 v18, 0
  v_mov_b32 v19, 0
  v_mov_b32 v20, 0
  v_mov_b32 v21, 0
  v_mov_b32 v22, 0
  v_mov_b32 v23, 0
  v_mov_b32 v24, 0
  v_mov_b32 v25, 0
  v_mov_b32 v26, 0
  v_mov_b32 v27, 0
  v_mov_b32 v28, 0
  v_mov_b32 v29, 0
  v_mov_b32 v30, 0
  v_mov_b32 v31, 0
  s_cmp_eq_u32 s7, 3
  s_cselect_b32 s74, 0x00ff00ff, -1
  s_mov_b32 s72, 0
  s_mov_b32 s73, 3584
  s_mov_b32 exec_lo, s74
  s_mov_b32 exec_hi, s74
  buffer_load_dwordx4 v[0:3], v94, s[24:27], s72 offen
  buffer_load_dwordx4 v[4:7], v94, s[24:27], s72 offen offset:896
  buffer_load_dwordx4 v[8:11], v94, s[24:27], s72 offen offset:1792
  buffer_load_dwordx4 v[12:15], v94, s[24:27], s72 offen offset:2688
  s_waitcnt vmcnt(0)
  buffer_load_dwordx4 v[16:19], v94, s[24:27], s73 offen
  buffer_load_dwordx4 v[20:23], v94, s[24:27], s73 offen offset:896
  buffer_load_dwordx4 v[24:27], v94, s[24:27], s73 offen offset:1792
  buffer_load_dwordx4 v[28:31], v94, s[24:27], s73 offen offset:2688
  s_waitcnt vmcnt(0)
  s_mov_b64 exec, -1
  s_waitcnt vmcnt(0)
  v_perm_b32 v32, v4, v0, s78
  v_perm_b32 v33, v12, v8, s78
  v_perm_b32 v34, v20, v16, s78
  v_perm_b32 v35, v28, v24, s78
  v_perm_b32 v36, v4, v0, s79
  v_perm_b32 v37, v12, v8, s79
  v_perm_b32 v38, v20, v16, s79
  v_perm_b32 v39, v28, v24, s79
  v_perm_b32 v40, v5, v1, s78
  v_perm_b32 v41, v13, v9, s78
  v_perm_b32 v42, v21, v17, s78
  v_perm_b32 v43, v29, v25, s78
  v_perm_b32 v44, v5, v1, s79
  v_perm_b32 v45, v13, v9, s79
  v_perm_b32 v46, v21, v17, s79
  v_perm_b32 v47, v29, v25, s79
  v_perm_b32 v48, v6, v2, s78
  v_perm_b32 v49, v14, v10, s78
  v_perm_b32 v50, v22, v18, s78
  v_perm_b32 v51, v30, v26, s78
  v_perm_b32 v52, v6, v2, s79
  v_perm_b32 v53, v14, v10, s79
  v_perm_b32 v54, v22, v18, s79
  v_perm_b32 v55, v30, v26, s79
  v_perm_b32 v56, v7, v3, s78
  v_perm_b32 v57, v15, v11, s78
  v_perm_b32 v58, v23, v19, s78
  v_perm_b32 v59, v31, v27, s78
  v_perm_b32 v60, v7, v3, s79
  v_perm_b32 v61, v15, v11, s79
  v_perm_b32 v62, v23, v19, s79
  v_perm_b32 v63, v31, v27, s79
  v_accvgpr_write_b32 a0, v32
  v_accvgpr_write_b32 a1, v33
  v_accvgpr_write_b32 a2, v34
  v_accvgpr_write_b32 a3, v35
  v_accvgpr_write_b32 a4, v36
  v_accvgpr_write_b32 a5, v37
  v_accvgpr_write_b32 a6, v38
  v_accvgpr_write_b32 a7, v39
  v_accvgpr_write_b32 a8, v40
  v_accvgpr_write_b32 a9, v41
  v_accvgpr_write_b32 a10, v42
  v_accvgpr_write_b32 a11, v43
  v_accvgpr_write_b32 a12, v44
  v_accvgpr_write_b32 a13, v45
  v_accvgpr_write_b32 a14, v46
  v_accvgpr_write_b32 a15, v47
  v_accvgpr_write_b32 a16, v48
  v_accvgpr_write_b32 a17, v49
  v_accvgpr_write_b32 a18, v50
  v_accvgpr_write_b32 a19, v51
  v_accvgpr_write_b32 a20, v52
  v_accvgpr_write_b32 a21, v53
  v_accvgpr_write_b32 a22, v54
  v_accvgpr_write_b32 a23, v55
  v_accvgpr_write_b32 a24, v56
  v_accvgpr_write_b32 a25, v57
  v_accvgpr_write_b32 a26, v58
  v_accvgpr_write_b32 a27, v59
  v_accvgpr_write_b32 a28, v60
  v_accvgpr_write_b32 a29, v61
  v_accvgpr_write_b32 a30, v62
  v_accvgpr_write_b32 a31, v63
  s_mov_b32 s72, 28672
  s_mov_b32 s73, 32256
  s_mov_b32 exec_lo, s74
  s_mov_b32 exec_hi, s74
  buffer_load_dwordx4 v[0:3], v94, s[24:27], s72 offen
  buffer_load_dwordx4 v[4:7], v94, s[24:27], s72 offen offset:896
  buffer_load_dwordx4 v[8:11], v94, s[24:27], s72 offen offset:1792
  buffer_load_dwordx4 v[12:15], v94, s[24:27], s72 offen offset:2688
  s_waitcnt vmcnt(0)
  buffer_load_dwordx4 v[16:19], v94, s[24:27], s73 offen
  buffer_load_dwordx4 v[20:23], v94, s[24:27], s73 offen offset:896
  buffer_load_dwordx4 v[24:27], v94, s[24:27], s73 offen offset:1792
  buffer_load_dwordx4 v[28:31], v94, s[24:27], s73 offen offset:2688
  s_waitcnt vmcnt(0)
  s_mov_b64 exec, -1
  s_waitcnt vmcnt(0)
  v_perm_b32 v32, v4, v0, s78
  v_perm_b32 v33, v12, v8, s78
  v_perm_b32 v34, v20, v16, s78
  v_perm_b32 v35, v28, v24, s78
  v_perm_b32 v36, v4, v0, s79
  v_perm_b32 v37, v12, v8, s79
  v_perm_b32 v38, v20, v16, s79
  v_perm_b32 v39, v28, v24, s79
  v_perm_b32 v40, v5, v1, s78
  v_perm_b32 v41, v13, v9, s78
  v_perm_b32 v42, v21, v17, s78
  v_perm_b32 v43, v29, v25, s78
  v_perm_b32 v44, v5, v1, s79
  v_perm_b32 v45, v13, v9, s79
  v_perm_b32 v46, v21, v17, s79
  v_perm_b32 v47, v29, v25, s79
  v_perm_b32 v48, v6, v2, s78
  v_perm_b32 v49, v14, v10, s78
  v_perm_b32 v50, v22, v18, s78
  v_perm_b32 v51, v30, v26, s78
  v_perm_b32 v52, v6, v2, s79
  v_perm_b32 v53, v14, v10, s79
  v_perm_b32 v54, v22, v18, s79
  v_perm_b32 v55, v30, v26, s79
  v_perm_b32 v56, v7, v3, s78
  v_perm_b32 v57, v15, v11, s78
  v_perm_b32 v58, v23, v19, s78
  v_perm_b32 v59, v31, v27, s78
  v_perm_b32 v60, v7, v3, s79
  v_perm_b32 v61, v15, v11, s79
  v_perm_b32 v62, v23, v19, s79
  v_perm_b32 v63, v31, v27, s79
  v_accvgpr_write_b32 a32, v32
  v_accvgpr_write_b32 a33, v33
  v_accvgpr_write_b32 a34, v34
  v_accvgpr_write_b32 a35, v35
  v_accvgpr_write_b32 a36, v36
  v_accvgpr_write_b32 a37, v37
  v_accvgpr_write_b32 a38, v38
  v_accvgpr_write_b32 a39, v39
  v_accvgpr_write_b32 a40, v40
  v_accvgpr_write_b32 a41, v41
  v_accvgpr_write_b32 a42, v42
  v_accvgpr_write_b32 a43, v43
  v_accvgpr_write_b32 a44, v44
  v_accvgpr_write_b32 a45, v45
  v_accvgpr_write_b32 a46, v46
  v_accvgpr_write_b32 a47, v47
  v_accvgpr_write_b32 a48, v48
  v_accvgpr_write_b32 a49, v49
  v_accvgpr_write_b32 a50, v50
  v_accvgpr_write_b32 a51, v51
  v_accvgpr_write_b32 a52, v52
  v_accvgpr_write_b32 a53, v53
  v_accvgpr_write_b32 a54, v54
  v_accvgpr_write_b32 a55, v55
  v_accvgpr_write_b32 a56, v56
  v_accvgpr_write_b32 a57, v57
  v_accvgpr_write_b32 a58, v58
  v_accvgpr_write_b32 a59, v59
  v_accvgpr_write_b32 a60, v60
  v_accvgpr_write_b32 a61, v61
  v_accvgpr_write_b32 a62, v62
  v_accvgpr_write_b32 a63, v63
  s_mov_b32 s72, 57344
  s_mov_b32 s73, 60928
  s_mov_b32 exec_lo, s74
  s_mov_b32 exec_hi, s74
  buffer_load_dwordx4 v[0:3], v94, s[24:27], s72 offen
  buffer_load_dwordx4 v[4:7], v94, s[24:27], s72 offen offset:896
  buffer_load_dwordx4 v[8:11], v94, s[24:27], s72 offen offset:1792
  buffer_load_dwordx4 v[12:15], v94, s[24:27], s72 offen offset:2688
  s_waitcnt vmcnt(0)
  buffer_load_dwordx4 v[16:19], v94, s[24:27], s73 offen
  buffer_load_dwordx4 v[20:23], v94, s[24:27], s73 offen offset:896
  buffer_load_dwordx4 v[24:27], v94, s[24:27], s73 offen offset:1792
  buffer_load_dwordx4 v[28:31], v94, s[24:27], s73 offen offset:2688
  s_waitcnt vmcnt(0)
  s_mov_b64 exec, -1
  s_waitcnt vmcnt(0)
  v_perm_b32 v32, v4, v0, s78
  v_perm_b32 v33, v12, v8, s78
  v_perm_b32 v34, v20, v16, s78
  v_perm_b32 v35, v28, v24, s78
  v_perm_b32 v36, v4, v0, s79
  v_perm_b32 v37, v12, v8, s79
  v_perm_b32 v38, v20, v16, s79
  v_perm_b32 v39, v28, v24, s79
  v_perm_b32 v40, v5, v1, s78
  v_perm_b32 v41, v13, v9, s78
  v_perm_b32 v42, v21, v17, s78
  v_perm_b32 v43, v29, v25, s78
  v_perm_b32 v44, v5, v1, s79
  v_perm_b32 v45, v13, v9, s79
  v_perm_b32 v46, v21, v17, s79
  v_perm_b32 v47, v29, v25, s79
  v_perm_b32 v48, v6, v2, s78
  v_perm_b32 v49, v14, v10, s78
  v_perm_b32 v50, v22, v18, s78
  v_perm_b32 v51, v30, v26, s78
  v_perm_b32 v52, v6, v2, s79
  v_perm_b32 v53, v14, v10, s79
  v_perm_b32 v54, v22, v18, s79
  v_perm_b32 v55, v30, v26, s79
  v_perm_b32 v56, v7, v3, s78
  v_perm_b32 v57, v15, v11, s78
  v_perm_b32 v58, v23, v19, s78
  v_perm_b32 v59, v31, v27, s78
  v_perm_b32 v60, v7, v3, s79
  v_perm_b32 v61, v15, v11, s79
  v_perm_b32 v62, v23, v19, s79
  v_perm_b32 v63, v31, v27, s79
  v_accvgpr_write_b32 a64, v32
  v_accvgpr_write_b32 a65, v33
  v_accvgpr_write_b32 a66, v34
  v_accvgpr_write_b32 a67, v35
  v_accvgpr_write_b32 a68, v36
  v_accvgpr_write_b32 a69, v37
  v_accvgpr_write_b32 a70, v38
  v_accvgpr_write_b32 a71, v39
  v_accvgpr_write_b32 a72, v40
  v_accvgpr_write_b32 a73, v41
  v_accvgpr_write_b32 a74, v42
  v_accvgpr_write_b32 a75, v43
  v_accvgpr_write_b32 a76, v44
  v_accvgpr_write_b32 a77, v45
  v_accvgpr_write_b32 a78, v46
  v_accvgpr_write_b32 a79, v47
  v_accvgpr_write_b32 a80, v48
  v_accvgpr_write_b32 a81, v49
  v_accvgpr_write_b32 a82, v50
  v_accvgpr_write_b32 a83, v51
  v_accvgpr_write_b32 a84, v52
  v_accvgpr_write_b32 a85, v53
  v_accvgpr_write_b32 a86, v54
  v_accvgpr_write_b32 a87, v55
  v_accvgpr_write_b32 a88, v56
  v_accvgpr_write_b32 a89, v57
  v_accvgpr_write_b32 a90, v58
  v_accvgpr_write_b32 a91, v59
  v_accvgpr_write_b32 a92, v60
  v_accvgpr_write_b32 a93, v61
  v_accvgpr_write_b32 a94, v62
  v_accvgpr_write_b32 a95, v63
  s_mov_b32 s72, 86016
  s_mov_b32 s73, 89600
  s_mov_b32 exec_lo, s74
  s_mov_b32 exec_hi, s74
  buffer_load_dwordx4 v[0:3], v94, s[24:27], s72 offen
  buffer_load_dwordx4 v[4:7], v94, s[24:27], s72 offen offset:896
  buffer_load_dwordx4 v[8:11], v94, s[24:27], s72 offen offset:1792
  buffer_load_dwordx4 v[12:15], v94, s[24:27], s72 offen offset:2688
  s_waitcnt vmcnt(0)
  buffer_load_dwordx4 v[16:19], v94, s[24:27], s73 offen
  buffer_load_dwordx4 v[20:23], v94, s[24:27], s73 offen offset:896
  buffer_load_dwordx4 v[24:27], v94, s[24:27], s73 offen offset:1792
  buffer_load_dwordx4 v[28:31], v94, s[24:27], s73 offen offset:2688
  s_waitcnt vmcnt(0)
  s_mov_b64 exec, -1
  s_waitcnt vmcnt(0)
  v_perm_b32 v32, v4, v0, s78
  v_perm_b32 v33, v12, v8, s78
  v_perm_b32 v34, v20, v16, s78
  v_perm_b32 v35, v28, v24, s78
  v_perm_b32 v36, v4, v0, s79
  v_perm_b32 v37, v12, v8, s79
  v_perm_b32 v38, v20, v16, s79
  v_perm_b32 v39, v28, v24, s79
  v_perm_b32 v40, v5, v1, s78
  v_perm_b32 v41, v13, v9, s78
  v_perm_b32 v42, v21, v17, s78
  v_perm_b32 v43, v29, v25, s78
  v_perm_b32 v44, v5, v1, s79
  v_perm_b32 v45, v13, v9, s79
  v_perm_b32 v46, v21, v17, s79
  v_perm_b32 v47, v29, v25, s79
  v_perm_b32 v48, v6, v2, s78
  v_perm_b32 v49, v14, v10, s78
  v_perm_b32 v50, v22, v18, s78
  v_perm_b32 v51, v30, v26, s78
  v_perm_b32 v52, v6, v2, s79
  v_perm_b32 v53, v14, v10, s79
  v_perm_b32 v54, v22, v18, s79
  v_perm_b32 v55, v30, v26, s79
  v_perm_b32 v56, v7, v3, s78
  v_perm_b32 v57, v15, v11, s78
  v_perm_b32 v58, v23, v19, s78
  v_perm_b32 v59, v31, v27, s78
  v_perm_b32 v60, v7, v3, s79
  v_perm_b32 v61, v15, v11, s79
  v_perm_b32 v62, v23, v19, s79
  v_perm_b32 v63, v31, v27, s79
  v_accvgpr_write_b32 a96, v32
  v_accvgpr_write_b32 a97, v33
  v_accvgpr_write_b32 a98, v34
  v_accvgpr_write_b32 a99, v35
  v_accvgpr_write_b32 a100, v36
  v_accvgpr_write_b32 a101, v37
  v_accvgpr_write_b32 a102, v38
  v_accvgpr_write_b32 a103, v39
  v_accvgpr_write_b32 a104, v40
  v_accvgpr_write_b32 a105, v41
  v_accvgpr_write_b32 a106, v42
  v_accvgpr_write_b32 a107, v43
  v_accvgpr_write_b32 a108, v44
  v_accvgpr_write_b32 a109, v45
  v_accvgpr_write_b32 a110, v46
  v_accvgpr_write_b32 a111, v47
  v_accvgpr_write_b32 a112, v48
  v_accvgpr_write_b32 a113, v49
  v_accvgpr_write_b32 a114, v50
  v_accvgpr_write_b32 a115, v51
  v_accvgpr_write_b32 a116, v52
  v_accvgpr_write_b32 a117, v53
  v_accvgpr_write_b32 a118, v54
  v_accvgpr_write_b32 a119, v55
  v_accvgpr_write_b32 a120, v56
  v_accvgpr_write_b32 a121, v57
  v_accvgpr_write_b32 a122, v58
  v_accvgpr_write_b32 a123, v59
  v_accvgpr_write_b32 a124, v60
  v_accvgpr_write_b32 a125, v61
  v_accvgpr_write_b32 a126, v62
  v_accvgpr_write_b32 a127, v63
  s_cmp_lg_u32 s7, 0
  s_cbranch_scc1 L_hclrok
  s_lshl_b32 s72, s83, 7
  s_add_u32 s72, s72, 0x760000
  v_and_b32 v95, 31, v64
  v_lshlrev_b32 v95, 2, v95
  s_mov_b32 s81, 262144
L_hclr:
  buffer_load_dword v96, v95, s[28:31], s72 offen sc1
  s_waitcnt vmcnt(0)
  v_cmp_ne_u32 vcc, s82, v96
  s_nop 1
  s_cbranch_vccz L_hclrok
  s_sleep 16
  s_sub_u32 s81, s81, 1
  s_cmp_lg_u32 s81, 0
  s_cbranch_scc1 L_hclr
L_hclrok:
  s_cmp_lg_u32 s7, 0
  s_cbranch_scc1 L_hbaldone
  v_mov_b32 v94, 136648
  s_mov_b32 s81, 262144
L_hb0:
  ds_read_b32 v0, v94
  s_waitcnt lgkmcnt(0)
  v_readfirstlane_b32 s72, v0
  s_nop 3
  s_cmp_ge_u32 s72, 44
  s_cbranch_scc1 L_hb0ok
  s_sleep 32
  s_sub_u32 s81, s81, 1
  s_cmp_lg_u32 s81, 0
  s_cbranch_scc1 L_hb0
L_hb0ok:
  s_memrealtime s[8:9]
  s_waitcnt lgkmcnt(0)
  s_lshl_b32 s73, s83, 7
  s_add_u32 s73, s73, 0x7a0000
  s_add_u32 s10, s46, s73
  s_addc_u32 s11, s47, 0
  s_and_b32 s76, s5, 1
  s_mul_i32 s76, s76, -20
  s_add_u32 s76, s76, 108
  s_mov_b32 s64, 116
  s_mov_b32 s65, 160
  s_mov_b32 s66, 0
  s_xor_b32 s67, s83, 8
  s_lshl_b32 s67, s67, 7
  s_add_u32 s67, s67, 0x7a0000
L_hbround:
  s_mov_b32 s81, 262144
L_hb1:
  ds_read_b32 v0, v94
  s_load_dwordx8 s[12:19], s[10:11], 0 glc
  s_waitcnt lgkmcnt(0)
  v_readfirstlane_b32 s74, v0
  s_nop 3
  s_cmp_ge_u32 s74, s76
  s_cbranch_scc1 L_hb1ok
  s_cmp_eq_u32 s17, s82
  s_cbranch_scc1 L_hb1ok
  s_sleep 12
  s_sub_u32 s81, s81, 1
  s_cmp_lg_u32 s81, 0
  s_cbranch_scc1 L_hb1
L_hb1ok:
  s_memrealtime s[20:21]
  s_waitcnt lgkmcnt(0)
  s_lshl_b32 s75, s74, 16
  s_or_b32 s75, s75, s72
  v_mov_b32 v4, s75
  v_mov_b32 v5, s82
  v_mov_b32 v6, s8
  v_mov_b32 v7, s82
  v_mov_b32 v8, s20
  v_mov_b32 v9, s82
  v_mov_b32 v10, 0
  s_mov_b64 exec, 1
  buffer_store_dwordx4 v[4:7], v10, s[28:31], s67 offen sc1
  buffer_store_dwordx2 v[8:9], v10, s[28:31], s67 offen offset:16 sc1
  s_mov_b32 s81, 262144
L_hb2:
  s_load_dwordx8 s[12:19], s[10:11], 0 glc
  s_waitcnt lgkmcnt(0)
  s_xor_b32 s22, s13, s82
  s_xor_b32 s23, s15, s82
  s_or_b32 s22, s22, s23
  s_xor_b32 s23, s17, s82
  s_or_b32 s22, s22, s23
  s_cmp_eq_u32 s22, 0
  s_cbranch_scc1 L_hb2ok
  s_sleep 4
  s_sub_u32 s81, s81, 1
  s_cmp_lg_u32 s81, 0
  s_cbranch_scc1 L_hb2
  v_mov_b32 v20, s64
  s_mov_b32 s66, 1
  s_branch L_hbn
L_hb2ok:
  s_and_b32 s73, s5, 1
  s_cmp_eq_u32 s73, 0
  s_cselect_b32 s22, s75, s12
  s_cselect_b32 s23, s8, s14
  s_cselect_b32 s9, s20, s16
  s_cselect_b32 s12, s12, s75
  s_cselect_b32 s14, s14, s8
  s_cselect_b32 s16, s16, s20
  s_lshr_b32 s13, s22, 16
  s_and_b32 s22, s22, 0xffff
  s_lshr_b32 s15, s12, 16
  s_and_b32 s12, s12, 0xffff
  s_sub_u32 s22, s13, s22
  s_sub_u32 s23, s9, s23
  s_sub_u32 s12, s15, s12
  s_sub_u32 s14, s16, s14
  s_sub_u32 s16, s16, s9
  v_cvt_f32_u32 v0, s22
  v_cvt_f32_u32 v1, s23
  v_cvt_f32_u32 v2, s12
  v_cvt_f32_u32 v3, s14
  v_cvt_f32_i32 v4, s16
  v_cvt_f32_u32 v5, s13
  v_cvt_f32_u32 v6, s15
  v_rcp_f32 v0, v0
  v_rcp_f32 v2, v2
  s_nop 0
  v_mul_f32 v1, v1, v0
  v_mul_f32 v3, v3, v2
  v_sub_f32 v6, 0x43800000, v6
  v_fmac_f32 v4, v5, v1
  v_fmac_f32 v4, v6, v3
  v_add_f32 v6, v1, v3
  v_rcp_f32 v6, v6
  s_nop 0
  v_mul_f32 v5, v4, v6
  v_add_f32 v5, 0.5, v5
  v_cvt_i32_f32 v20, v5
  v_max_i32 v20, s64, v20
  v_min_i32 v20, s65, v20
L_hbn:
  s_nop 0
  v_readfirstlane_b32 s22, v20
  s_nop 3
  v_mov_b32 v22, 136652
  s_cmp_lg_u32 s66, 0
  s_cbranch_scc1 L_hbfinal
  s_sub_u32 s23, s22, 5
  s_max_i32 s64, s64, s23
  s_sub_u32 s23, 251, s22
  s_max_i32 s23, s23, 96
  s_sub_u32 s65, 256, s23
  s_and_b32 s73, s5, 1
  s_cmp_eq_u32 s73, 0
  s_cselect_b32 s23, s64, s23
  v_mov_b32 v21, s23
  ds_write_b32 v22, v21
  s_sub_u32 s76, s23, 6
  s_mov_b32 s8, s20
  s_mov_b32 s72, s74
  s_add_u32 s10, s10, 32
  s_addc_u32 s11, s11, 0
  s_add_u32 s67, s67, 32
  s_mov_b32 s66, 1
  s_mov_b64 exec, -1
  s_branch L_hbround
L_hbfinal:
  s_and_b32 s73, s5, 1
  s_cmp_eq_u32 s73, 0
  s_cbranch_scc1 L_hb3
  s_sub_u32 s22, 256, s22
L_hb3:
  v_mov_b32 v20, s22
  v_mov_b32 v21, 1
  ds_write_b32 v22, v20
  s_waitcnt lgkmcnt(0)
  ds_write_b32 v22, v21 offset:4
  s_mov_b64 exec, -1
L_hbaldone:
  s_mov_b32 s66, 0x3db8aa3b
  s_lshl_b32 s72, s68, 2
  s_add_u32 s72, s72, s5
  s_mul_i32 s72, s72, 8704
  s_add_u32 s73, s72, 2176
  s_add_u32 s74, s72, 4352
  s_add_u32 s75, s72, 6528
  v_and_b32 v108, 3, v64
  v_lshlrev_b32 v108, 3, v108
  v_and_b32 v109, 3, v64
  s_movk_i32 s76, 272
  v_mul_lo_u32 v109, v109, s76
  v_lshrrev_b32 v94, 2, v64
  v_lshl_add_u32 v109, v94, 4, v109
  v_add_u32 v109, 135552, v109
  v_and_b32 v110, 3, v65
  v_mul_lo_u32 v110, v110, s76
  v_lshl_add_u32 v110, v66, 4, v110
  v_add_u32 v110, 135552, v110
  v_lshlrev_b32 v111, 6, v66
  v_lshl_add_u32 v111, v65, 4, v111
  v_lshlrev_b32 v112, 16, v66
  v_lshl_add_u32 v112, v65, 4, v112
  v_and_b32 v113, 3, v65
  s_lshl_b32 s76, s6, 2
  v_add_u32 v113, s76, v113
  s_movk_i32 s76, 896
  v_mul_lo_u32 v113, v113, s76
  v_lshrrev_b32 v94, 2, v65
  v_lshl_add_u32 v113, v94, 6, v113
  s_lshl_b32 s58, s6, 18
  s_lshr_b32 s76, s69, 3
  s_lshl_b32 s76, s76, 11
  s_add_u32 s58, s58, s76
  s_and_b32 s76, s69, 7
  s_lshl_b32 s76, s76, 8
  s_add_u32 s58, s58, s76
  s_add_u32 s58, s58, 0x400000
  s_lshr_b32 s59, s69, 3
  s_mul_i32 s59, s59, 256
  s_and_b32 s76, s69, 7
  s_lshl_b32 s76, s76, 1
  s_add_u32 s59, s59, s76
  s_barrier
  s_cmp_lg_u32 s7, 0
  s_cbranch_scc1 L_t3done
  s_mov_b32 s81, 262144
L_poll1:
  buffer_load_dwordx4 v[0:3], v104, s[28:31], s72 offen sc1
  buffer_load_dwordx4 v[4:7], v104, s[28:31], s72 offen offset:1024 sc1
  buffer_load_dwordx2 v[32:33], v108, s[28:31], s72 offen offset:2048 sc1
  buffer_load_dwordx4 v[8:11], v104, s[28:31], s73 offen sc1
  buffer_load_dwordx4 v[12:15], v104, s[28:31], s73 offen offset:1024 sc1
  buffer_load_dwordx2 v[34:35], v108, s[28:31], s73 offen offset:2048 sc1
  buffer_load_dwordx4 v[16:19], v104, s[28:31], s74 offen sc1
  buffer_load_dwordx4 v[20:23], v104, s[28:31], s74 offen offset:1024 sc1
  buffer_load_dwordx2 v[36:37], v108, s[28:31], s74 offen offset:2048 sc1
  buffer_load_dwordx4 v[24:27], v104, s[28:31], s75 offen sc1
  buffer_load_dwordx4 v[28:31], v104, s[28:31], s75 offen offset:1024 sc1
  buffer_load_dwordx2 v[38:39], v108, s[28:31], s75 offen offset:2048 sc1
  s_waitcnt vmcnt(0)
  v_max3_u32 v95, v0, v1, v2
  v_max3_u32 v95, v95, v3, v4
  v_max3_u32 v95, v95, v5, v6
  v_max3_u32 v95, v95, v7, v8
  v_max3_u32 v95, v95, v9, v10
  v_max3_u32 v95, v95, v11, v12
  v_max3_u32 v95, v95, v13, v14
  v_max3_u32 v95, v95, v15, v16
  v_max3_u32 v95, v95, v17, v18
  v_max3_u32 v95, v95, v19, v20
  v_max3_u32 v95, v95, v21, v22
  v_max3_u32 v95, v95, v23, v24
  v_max3_u32 v95, v95, v25, v26
  v_max3_u32 v95, v95, v27, v28
  v_max3_u32 v95, v95, v29, v30
  v_max3_u32 v95, v95, v31, v32
  v_max3_u32 v95, v95, v33, v34
  v_max3_u32 v95, v95, v35, v36
  v_max3_u32 v95, v95, v37, v38
  v_max_u32 v95, v95, v39
  v_cmp_eq_u32 vcc, -1, v95
  s_nop 1
  s_cbranch_vccz L_poll1ok
  s_sub_u32 s81, s81, 1
  s_cmp_lg_u32 s81, 0
  s_cbranch_scc1 L_poll1
L_poll1ok:
  v_max3_f32 v96, v32, v34, v36
  v_max_f32 v96, v96, v38
  v_sub_f32 v98, v32, v96
  v_sub_f32 v99, v34, v96
  v_sub_f32 v100, v36, v96
  v_sub_f32 v101, v38, v96
  v_mul_f32 v98, s66, v98
  v_mul_f32 v99, s66, v99
  v_mul_f32 v100, s66, v100
  v_mul_f32 v101, s66, v101
  v_exp_f32 v98, v98
  v_exp_f32 v99, v99
  v_exp_f32 v100, v100
  v_exp_f32 v101, v101
  s_nop 0
  v_mul_f32 v96, v98, v33
  v_fmac_f32 v96, v99, v35
  v_fmac_f32 v96, v100, v37
  v_fmac_f32 v96, v101, v39
  v_rcp_f32 v96, v96
  s_nop 0
  v_mul_f32 v98, v98, v96
  v_mul_f32 v99, v99, v96
  v_mul_f32 v100, v100, v96
  v_mul_f32 v101, v101, v96
  v_mul_f32 v32, v98, v0
  v_mul_f32 v33, v98, v1
  v_mul_f32 v34, v98, v2
  v_mul_f32 v35, v98, v3
  v_mul_f32 v36, v98, v4
  v_mul_f32 v37, v98, v5
  v_mul_f32 v38, v98, v6
  v_mul_f32 v39, v98, v7
  v_fmac_f32 v32, v99, v8
  v_fmac_f32 v33, v99, v9
  v_fmac_f32 v34, v99, v10
  v_fmac_f32 v35, v99, v11
  v_fmac_f32 v36, v99, v12
  v_fmac_f32 v37, v99, v13
  v_fmac_f32 v38, v99, v14
  v_fmac_f32 v39, v99, v15
  v_fmac_f32 v32, v100, v16
  v_fmac_f32 v33, v100, v17
  v_fmac_f32 v34, v100, v18
  v_fmac_f32 v35, v100, v19
  v_fmac_f32 v36, v100, v20
  v_fmac_f32 v37, v100, v21
  v_fmac_f32 v38, v100, v22
  v_fmac_f32 v39, v100, v23
  v_fmac_f32 v32, v101, v24
  v_fmac_f32 v33, v101, v25
  v_fmac_f32 v34, v101, v26
  v_fmac_f32 v35, v101, v27
  v_fmac_f32 v36, v101, v28
  v_fmac_f32 v37, v101, v29
  v_fmac_f32 v38, v101, v30
  v_fmac_f32 v39, v101, v31
  v_cvt_pk_bf16_f32 v0, v32, v33
  v_cvt_pk_bf16_f32 v1, v34, v35
  v_cvt_pk_bf16_f32 v2, v36, v37
  v_cvt_pk_bf16_f32 v3, v38, v39
  ds_write_b128 v109, v[0:3]
L_t3done:
  s_waitcnt lgkmcnt(0)
  s_barrier
  ds_read_b128 v[40:43], v110
  ds_read_b128 v[44:47], v110 offset:64
  ds_read_b128 v[48:51], v110 offset:128
  ds_read_b128 v[52:55], v110 offset:192
  s_waitcnt lgkmcnt(0)
  v_mfma_f32_16x16x32_bf16 v[0:3], a[0:3], v[40:43], 0
  v_mfma_f32_16x16x32_bf16 v[4:7], a[4:7], v[40:43], 0
  v_mfma_f32_16x16x32_bf16 v[8:11], a[8:11], v[40:43], 0
  v_mfma_f32_16x16x32_bf16 v[12:15], a[12:15], v[40:43], 0
  v_mfma_f32_16x16x32_bf16 v[16:19], a[16:19], v[40:43], 0
  v_mfma_f32_16x16x32_bf16 v[20:23], a[20:23], v[40:43], 0
  v_mfma_f32_16x16x32_bf16 v[24:27], a[24:27], v[40:43], 0
  v_mfma_f32_16x16x32_bf16 v[28:31], a[28:31], v[40:43], 0
  v_mfma_f32_16x16x32_bf16 v[0:3], a[32:35], v[44:47], v[0:3]
  v_mfma_f32_16x16x32_bf16 v[4:7], a[36:39], v[44:47], v[4:7]
  v_mfma_f32_16x16x32_bf16 v[8:11], a[40:43], v[44:47], v[8:11]
  v_mfma_f32_16x16x32_bf16 v[12:15], a[44:47], v[44:47], v[12:15]
  v_mfma_f32_16x16x32_bf16 v[16:19], a[48:51], v[44:47], v[16:19]
  v_mfma_f32_16x16x32_bf16 v[20:23], a[52:55], v[44:47], v[20:23]
  v_mfma_f32_16x16x32_bf16 v[24:27], a[56:59], v[44:47], v[24:27]
  v_mfma_f32_16x16x32_bf16 v[28:31], a[60:63], v[44:47], v[28:31]
  v_mfma_f32_16x16x32_bf16 v[0:3], a[64:67], v[48:51], v[0:3]
  v_mfma_f32_16x16x32_bf16 v[4:7], a[68:71], v[48:51], v[4:7]
  v_mfma_f32_16x16x32_bf16 v[8:11], a[72:75], v[48:51], v[8:11]
  v_mfma_f32_16x16x32_bf16 v[12:15], a[76:79], v[48:51], v[12:15]
  v_mfma_f32_16x16x32_bf16 v[16:19], a[80:83], v[48:51], v[16:19]
  v_mfma_f32_16x16x32_bf16 v[20:23], a[84:87], v[48:51], v[20:23]
  v_mfma_f32_16x16x32_bf16 v[24:27], a[88:91], v[48:51], v[24:27]
  v_mfma_f32_16x16x32_bf16 v[28:31], a[92:95], v[48:51], v[28:31]
  v_mfma_f32_16x16x32_bf16 v[0:3], a[96:99], v[52:55], v[0:3]
  v_mfma_f32_16x16x32_bf16 v[4:7], a[100:103], v[52:55], v[4:7]
  v_mfma_f32_16x16x32_bf16 v[8:11], a[104:107], v[52:55], v[8:11]
  v_mfma_f32_16x16x32_bf16 v[12:15], a[108:111], v[52:55], v[12:15]
  v_mfma_f32_16x16x32_bf16 v[16:19], a[112:115], v[52:55], v[16:19]
  v_mfma_f32_16x16x32_bf16 v[20:23], a[116:119], v[52:55], v[20:23]
  v_mfma_f32_16x16x32_bf16 v[24:27], a[120:123], v[52:55], v[24:27]
  v_mfma_f32_16x16x32_bf16 v[28:31], a[124:127], v[52:55], v[28:31]
  s_mov_b32 exec_lo, 0x000f000f
  s_mov_b32 exec_hi, 0x000f000f
  s_nop 5
  buffer_store_dwordx4 v[0:3], v111, s[28:31], s71 offen offset:0 sc1
  buffer_store_dwordx4 v[4:7], v111, s[28:31], s71 offen offset:256 sc1
  buffer_store_dwordx4 v[8:11], v111, s[28:31], s71 offen offset:512 sc1
  buffer_store_dwordx4 v[12:15], v111, s[28:31], s71 offen offset:768 sc1
  buffer_store_dwordx4 v[16:19], v111, s[28:31], s71 offen offset:1024 sc1
  buffer_store_dwordx4 v[20:23], v111, s[28:31], s71 offen offset:1280 sc1
  buffer_store_dwordx4 v[24:27], v111, s[28:31], s71 offen offset:1536 sc1
  buffer_store_dwordx4 v[28:31], v111, s[28:31], s71 offen offset:1792 sc1
  s_mov_b64 exec, -1
  s_cmp_lg_u32 s7, 0
  s_cbranch_scc1 L_fin
  s_mov_b32 s81, 262144
  buffer_load_dwordx4 v[64:67], v112, s[28:31], s58 offen sc1
  s_add_u32 s73, s58, 8192
  buffer_load_dwordx4 v[68:71], v112, s[28:31], s73 offen sc1
  s_add_u32 s73, s58, 16384
  buffer_load_dwordx4 v[72:75], v112, s[28:31], s73 offen sc1
  s_add_u32 s73, s58, 24576
  buffer_load_dwordx4 v[76:79], v112, s[28:31], s73 offen sc1
  s_add_u32 s73, s58, 32768
  buffer_load_dwordx4 v[80:83], v112, s[28:31], s73 offen sc1
  s_add_u32 s73, s58, 40960
  buffer_load_dwordx4 v[84:87], v112, s[28:31], s73 offen sc1
  s_add_u32 s73, s58, 49152
  buffer_load_dwordx4 v[88:91], v112, s[28:31], s73 offen sc1
  s_add_u32 s73, s58, 57344
  buffer_load_dwordx4 v[92:95], v112, s[28:31], s73 offen sc1
  buffer_load_dwordx4 v[0:3], v112, s[28:31], s58 offen sc1
  s_add_u32 s73, s58, 8192
  buffer_load_dwordx4 v[4:7], v112, s[28:31], s73 offen sc1
  s_add_u32 s73, s58, 16384
  buffer_load_dwordx4 v[8:11], v112, s[28:31], s73 offen sc1
  s_add_u32 s73, s58, 24576
  buffer_load_dwordx4 v[12:15], v112, s[28:31], s73 offen sc1
  s_add_u32 s73, s58, 32768
  buffer_load_dwordx4 v[16:19], v112, s[28:31], s73 offen sc1
  s_add_u32 s73, s58, 40960
  buffer_load_dwordx4 v[20:23], v112, s[28:31], s73 offen sc1
  s_add_u32 s73, s58, 49152
  buffer_load_dwordx4 v[24:27], v112, s[28:31], s73 offen sc1
  s_add_u32 s73, s58, 57344
  buffer_load_dwordx4 v[28:31], v112, s[28:31], s73 offen sc1
L_poll2:
  s_waitcnt vmcnt(8)
  v_max3_u32 v60, v64, v65, v66
  v_max3_u32 v60, v60, v67, v68
  v_max3_u32 v60, v60, v69, v70
  v_max3_u32 v60, v60, v71, v72
  v_max3_u32 v60, v60, v73, v74
  v_max3_u32 v60, v60, v75, v76
  v_max3_u32 v60, v60, v77, v78
  v_max3_u32 v60, v60, v79, v80
  v_max3_u32 v60, v60, v81, v82
  v_max3_u32 v60, v60, v83, v84
  v_max3_u32 v60, v60, v85, v86
  v_max3_u32 v60, v60, v87, v88
  v_max3_u32 v60, v60, v89, v90
  v_max3_u32 v60, v60, v91, v92
  v_max3_u32 v60, v60, v93, v94
  v_max_u32 v60, v60, v95
  v_cmp_eq_u32 vcc, -1, v60
  s_nop 1
  s_cbranch_vccz L_poll2okA
  buffer_load_dwordx4 v[64:67], v112, s[28:31], s58 offen sc1
  s_add_u32 s73, s58, 8192
  buffer_load_dwordx4 v[68:71], v112, s[28:31], s73 offen sc1
  s_add_u32 s73, s58, 16384
  buffer_load_dwordx4 v[72:75], v112, s[28:31], s73 offen sc1
  s_add_u32 s73, s58, 24576
  buffer_load_dwordx4 v[76:79], v112, s[28:31], s73 offen sc1
  s_add_u32 s73, s58, 32768
  buffer_load_dwordx4 v[80:83], v112, s[28:31], s73 offen sc1
  s_add_u32 s73, s58, 40960
  buffer_load_dwordx4 v[84:87], v112, s[28:31], s73 offen sc1
  s_add_u32 s73, s58, 49152
  buffer_load_dwordx4 v[88:91], v112, s[28:31], s73 offen sc1
  s_add_u32 s73, s58, 57344
  buffer_load_dwordx4 v[92:95], v112, s[28:31], s73 offen sc1
  s_waitcnt vmcnt(8)
  v_max3_u32 v60, v0, v1, v2
  v_max3_u32 v60, v60, v3, v4
  v_max3_u32 v60, v60, v5, v6
  v_max3_u32 v60, v60, v7, v8
  v_max3_u32 v60, v60, v9, v10
  v_max3_u32 v60, v60, v11, v12
  v_max3_u32 v60, v60, v13, v14
  v_max3_u32 v60, v60, v15, v16
  v_max3_u32 v60, v60, v17, v18
  v_max3_u32 v60, v60, v19, v20
  v_max3_u32 v60, v60, v21, v22
  v_max3_u32 v60, v60, v23, v24
  v_max3_u32 v60, v60, v25, v26
  v_max3_u32 v60, v60, v27, v28
  v_max3_u32 v60, v60, v29, v30
  v_max_u32 v60, v60, v31
  v_cmp_eq_u32 vcc, -1, v60
  s_nop 1
  s_cbranch_vccz L_poll2okB
  buffer_load_dwordx4 v[0:3], v112, s[28:31], s58 offen sc1
  s_add_u32 s73, s58, 8192
  buffer_load_dwordx4 v[4:7], v112, s[28:31], s73 offen sc1
  s_add_u32 s73, s58, 16384
  buffer_load_dwordx4 v[8:11], v112, s[28:31], s73 offen sc1
  s_add_u32 s73, s58, 24576
  buffer_load_dwordx4 v[12:15], v112, s[28:31], s73 offen sc1
  s_add_u32 s73, s58, 32768
  buffer_load_dwordx4 v[16:19], v112, s[28:31], s73 offen sc1
  s_add_u32 s73, s58, 40960
  buffer_load_dwordx4 v[20:23], v112, s[28:31], s73 offen sc1
  s_add_u32 s73, s58, 49152
  buffer_load_dwordx4 v[24:27], v112, s[28:31], s73 offen sc1
  s_add_u32 s73, s58, 57344
  buffer_load_dwordx4 v[28:31], v112, s[28:31], s73 offen sc1
  s_sub_u32 s81, s81, 1
  s_cmp_lg_u32 s81, 0
  s_cbranch_scc1 L_poll2
L_poll2okA:
  v_add_f32 v32, v64, v68
  v_add_f32 v33, v65, v69
  v_add_f32 v34, v66, v70
  v_add_f32 v35, v67, v71
  v_add_f32 v32, v32, v72
  v_add_f32 v33, v33, v73
  v_add_f32 v34, v34, v74
  v_add_f32 v35, v35, v75
  v_add_f32 v32, v32, v76
  v_add_f32 v33, v33, v77
  v_add_f32 v34, v34, v78
  v_add_f32 v35, v35, v79
  v_add_f32 v32, v32, v80
  v_add_f32 v33, v33, v81
  v_add_f32 v34, v34, v82
  v_add_f32 v35, v35, v83
  v_add_f32 v32, v32, v84
  v_add_f32 v33, v33, v85
  v_add_f32 v34, v34, v86
  v_add_f32 v35, v35, v87
  v_add_f32 v32, v32, v88
  v_add_f32 v33, v33, v89
  v_add_f32 v34, v34, v90
  v_add_f32 v35, v35, v91
  v_add_f32 v32, v32, v92
  v_add_f32 v33, v33, v93
  v_add_f32 v34, v34, v94
  v_add_f32 v35, v35, v95
  s_branch L_poll2done
L_poll2okB:
  v_add_f32 v32, v0, v4
  v_add_f32 v33, v1, v5
  v_add_f32 v34, v2, v6
  v_add_f32 v35, v3, v7
  v_add_f32 v32, v32, v8
  v_add_f32 v33, v33, v9
  v_add_f32 v34, v34, v10
  v_add_f32 v35, v35, v11
  v_add_f32 v32, v32, v12
  v_add_f32 v33, v33, v13
  v_add_f32 v34, v34, v14
  v_add_f32 v35, v35, v15
  v_add_f32 v32, v32, v16
  v_add_f32 v33, v33, v17
  v_add_f32 v34, v34, v18
  v_add_f32 v35, v35, v19
  v_add_f32 v32, v32, v20
  v_add_f32 v33, v33, v21
  v_add_f32 v34, v34, v22
  v_add_f32 v35, v35, v23
  v_add_f32 v32, v32, v24
  v_add_f32 v33, v33, v25
  v_add_f32 v34, v34, v26
  v_add_f32 v35, v35, v27
  v_add_f32 v32, v32, v28
  v_add_f32 v33, v33, v29
  v_add_f32 v34, v34, v30
  v_add_f32 v35, v35, v31
L_poll2done:
  v_mov_b32 v36, v32
  v_mov_b32 v37, v33
  v_mov_b32 v38, v34
  v_mov_b32 v39, v35
  s_nop 0
  v_permlane32_swap_b32 v36, v32
  v_permlane32_swap_b32 v37, v33
  v_permlane32_swap_b32 v38, v34
  v_permlane32_swap_b32 v39, v35
  v_add_f32 v32, v32, v36
  v_add_f32 v33, v33, v37
  v_add_f32 v34, v34, v38
  v_add_f32 v35, v35, v39
  v_mov_b32 v36, v32
  v_mov_b32 v37, v33
  v_mov_b32 v38, v34
  v_mov_b32 v39, v35
  s_nop 0
  v_permlane16_swap_b32 v36, v32
  v_permlane16_swap_b32 v37, v33
  v_permlane16_swap_b32 v38, v34
  v_permlane16_swap_b32 v39, v35
  v_add_f32 v32, v32, v36
  v_add_f32 v33, v33, v37
  v_add_f32 v34, v34, v38
  v_add_f32 v35, v35, v39
  v_cvt_pk_bf16_f32 v40, v32, v33
  v_cvt_pk_bf16_f32 v41, v34, v35
  s_cmp_ge_u32 s69, 24
  s_cselect_b32 s73, 0xff, -1
  s_and_b32 exec_lo, s73, 0xffff
  s_mov_b32 exec_hi, 0
  buffer_store_short v40, v113, s[48:51], s59 offen
  buffer_store_short_d16_hi v40, v113, s[48:51], s59 offen offset:16
  buffer_store_short v41, v113, s[48:51], s59 offen offset:32
  buffer_store_short_d16_hi v41, v113, s[48:51], s59 offen offset:48
  s_cmp_lg_u32 s83, 0
  s_cbranch_scc1 L_noep
  s_mov_b64 exec, 1
  v_mov_b32 v42, s60
  v_mov_b32 v43, s61
  v_mov_b32 v44, 0
  s_mov_b32 s72, 0x790000
  buffer_store_dwordx2 v[42:43], v44, s[28:31], s72 offen sc1
L_noep:
  s_mov_b64 exec, -1
L_fin:
L_end:
  s_endpgm
.section .rodata,"a"
.p2align 6
.amdhsa_kernel standalone__gqa_block_cached__sampling_kernel
  .amdhsa_next_free_vgpr 256
  .amdhsa_next_free_sgpr 102
  .amdhsa_accum_offset 128
  .amdhsa_group_segment_fixed_size 0
  .amdhsa_kernarg_size 64
  .amdhsa_user_sgpr_count 2
  .amdhsa_user_sgpr_kernarg_segment_ptr 1
  .amdhsa_system_sgpr_workgroup_id_x 1
.end_amdhsa_kernel
```
